```python
import torch

def _softmax(x, axis=-1):
    return torch.softmax(x, dim=axis)
def _gelu(x):
    return torch.nn.functional.gelu(x, approximate="tanh")
def _silu(x):
    return torch.nn.functional.silu(x)
def _sigmoid(x):
    return torch.sigmoid(x)
def _layernorm(x, axis=-1, eps=1e-5):
    m = x.mean(dim=axis, keepdim=True)
    v = x.var(dim=axis, keepdim=True, unbiased=False)
    return (x - m) / torch.sqrt(v + eps)
def _scatter_add(tgt, idx, src, axis=0):
    return tgt.clone().index_add_(axis, idx, src)
def _segment_sum(src, seg, n):
    out = torch.zeros((n,) + src.shape[1:], dtype=src.dtype)
    return out.index_add_(0, seg, src)
def _pad(x, pw):
    flat = tuple(v for pair in reversed(pw) for v in pair)
    return torch.nn.functional.pad(x, flat)

kernel_name = 'parallel_sum__gqa_block_cached__geglu_ffn__decode'

def setup_inputs():

    _w = (lambda a: (lambda t: t.to(torch.bfloat16) if t.is_floating_point() else t)(torch.as_tensor(a)))
    def _A_setup():
        B, Sq, D = 2, 1, 1024
        Hq, Hkv, Sk, Dh = 32, 4, 32768, 128
        assert Hq % Hkv == 0, (Hq, Hkv)
        return {
            "x": _w((lambda *s: torch.randn(*s, dtype=torch.bfloat16) * 0.05)(B, Sq, D)),
            "k_cache": _w((lambda *s: torch.randn(*s, dtype=torch.bfloat16) * 3.2)(B, Hkv, Sk, Dh)),
            "v_cache": _w((lambda *s: torch.randn(*s, dtype=torch.bfloat16) * 1.6)(B, Hkv, Sk, Dh)),
            "wq": _w((lambda *s: torch.randn(*s, dtype=torch.bfloat16) * 3.2)(D, Hq * Dh) * (D ** -0.5)),
            "wo": _w((lambda *s: torch.randn(*s, dtype=torch.bfloat16) * 1.6)(Hq * Dh, D) * ((Hq * Dh) ** -0.5)),
        }
    _A_in = _A_setup()

    def _B_setup():
        B, S, D, F = 2, 1, 1024, 3584
        return {
            "x": _w((lambda *s: torch.randn(*s, dtype=torch.bfloat16) * 0.05)(B, S, D)),
            "w_gate": _w((lambda *s: torch.randn(*s, dtype=torch.bfloat16) * 0.05)(D, F)),
            "w_up": _w((lambda *s: torch.randn(*s, dtype=torch.bfloat16) * 0.05)(D, F)),
            "w_down": _w((lambda *s: torch.randn(*s, dtype=torch.bfloat16) * 0.05)(F, D)),
        }
    _B_in = _B_setup()

    return {
        "A_x": _A_in["x"],
        "A_k_cache": _A_in["k_cache"],
        "A_v_cache": _A_in["v_cache"],
        "A_wq": _A_in["wq"],
        "A_wo": _A_in["wo"],
        "B_x": _B_in["x"],
        "B_w_gate": _B_in["w_gate"],
        "B_w_up": _B_in["w_up"],
        "B_w_down": _B_in["w_down"],
    }

def reference(A_x, A_k_cache, A_v_cache, A_wq, A_wo, B_x, B_w_gate, B_w_up, B_w_down):
    def _A_ref(x, k_cache, v_cache, wq, wo):
        B, Sq, D = x.shape
        Hq, Dh = 32, 128
        Hkv = k_cache.shape[1]
        rep = Hq // Hkv
        q = (lambda x, *d: x.permute(*d))((x @ wq).reshape(B, Sq, Hq, Dh), 0, 2, 1, 3)
        k = (lambda x, n, axis: torch.repeat_interleave(x, n, dim=axis))(k_cache, rep, axis=1)
        v = (lambda x, n, axis: torch.repeat_interleave(x, n, dim=axis))(v_cache, rep, axis=1)
        scores = torch.einsum("bhqd,bhkd->bhqk", q, k) * (Dh ** -0.5)
        p = _softmax(scores, axis=-1)
        o = torch.einsum("bhqk,bhkd->bhqd", p, v)
        return (lambda x, *d: x.permute(*d))(o, 0, 2, 1, 3).reshape(B, Sq, Hq * Dh) @ wo

    def _B_ref(x, w_gate, w_up, w_down):
        return (_gelu(x @ w_gate) * (x @ w_up)) @ w_down

    x = A_x
    xn = _layernorm(x, axis=-1)
    return x + _A_ref(xn, A_k_cache, A_v_cache, A_wq, A_wo) + _B_ref(xn, B_w_gate, B_w_up, B_w_down)
```

```asm
; @launch grid=(256,1,1) block=(512,1,1) lds=163840
.amdgcn_target "amdgcn-amd-amdhsa--gfx950"
.text
.globl parallel_sum__gqa_block_cached__geglu_ffn__decode_kernel
.p2align 8
.type parallel_sum__gqa_block_cached__geglu_ffn__decode_kernel,@function
parallel_sum__gqa_block_cached__geglu_ffn__decode_kernel:
    s_cmp_ge_u32 s2, 256
    s_cbranch_scc1 L_end
    s_load_dwordx16 s[4:19], s[0:1], 0
    s_load_dwordx8 s[20:27], s[0:1], 64
    v_lshrrev_b32 v168, 6, v0
    v_and_b32 v1, 63, v0
    v_readfirstlane_b32 s65, v168
    s_and_b32 s49, s2, 7
    s_lshr_b32 s54, s2, 3
    s_lshr_b32 s46, s2, 6
    s_mov_b32 s45, s54
    s_and_b32 s45, s45, 7
    s_lshl_b32 s45, s45, 3
    s_add_u32 s45, s45, s49
    s_and_b32 s44, s65, 3
    s_lshl_b32 s47, s44, 15
    v_lshrrev_b32 v171, 3, v1
    v_and_b32 v172, 7, v1
    v_lshlrev_b32 v172, 4, v172
    v_lshl_add_u32 v8, v171, 13, v172
    s_lshl_b32 s63, s46, 5
    s_add_u32 s63, s63, s44
    s_lshl_b32 s62, s45, 7
    s_lshl_b32 s60, s63, 16
    s_add_u32 s60, s60, s62
    v_lshrrev_b32 v174, 5, v1
    v_and_b32 v175, 31, v1
    v_lshlrev_b32 v175, 4, v175
    v_lshl_add_u32 v174, v174, 11, v175
    s_lshl_b32 s64, s46, 9
    v_add_u32 v176, s64, v174
    v_xor_b32 v177, 512, v176
    v_xor_b32 v178, 1024, v176
    v_xor_b32 v179, 1536, v176
    v_mov_b32 v5, 0
    v_lshlrev_b32 v169, 2, v1
    v_add_u32 v169, 161792, v169
    ds_write_b32 v169, v5
    s_mov_b32 s38, 0x800000
    s_mov_b32 s39, 0x20000
    s_mov_b32 m0, s47
    s_cmp_ge_u32 s65, 4
    s_waitcnt lgkmcnt(0)
    s_cbranch_scc1 L_loader
    global_load_dwordx4 v[184:187], v176, s[4:5]
    global_load_dwordx4 v[188:191], v177, s[4:5]
    global_load_dwordx4 v[192:195], v178, s[4:5]
    global_load_dwordx4 v[196:199], v179, s[4:5]
    s_load_dword s48, s[26:27], 0
    s_barrier
    s_branch L_consumer
L_loader:
    s_mov_b32 s36, s10
    s_mov_b32 s37, s11
    s_setprio 3
    buffer_load_dwordx4 v8, s[36:39], s60 offen offset:0 nt lds
    s_add_u32 s60, s60, 261120
    buffer_load_dwordx4 v8, s[36:39], s60 offen offset:1024 nt lds
    s_add_u32 s60, s60, 261120
    buffer_load_dwordx4 v8, s[36:39], s60 offen offset:2048 nt lds
    s_add_u32 s60, s60, 261120
    buffer_load_dwordx4 v8, s[36:39], s60 offen offset:3072 nt lds
    s_add_u32 s60, s60, 265216
    s_mov_b32 s70, 0
    s_mov_b32 s52, 0
    s_lshl_b32 s64, s44, 4
    s_add_u32 s64, s64, 161792
    v_mov_b32 v2, s64
    s_add_u32 m0, s47, 4096
    s_nop 0
    buffer_load_dwordx4 v8, s[36:39], s60 offen offset:0 nt lds
    s_add_u32 s60, s60, 261120
    s_barrier
    s_waitcnt vmcnt(4)
    buffer_load_dwordx4 v8, s[36:39], s60 offen offset:1024 nt lds
    s_add_u32 s60, s60, 261120
    s_waitcnt vmcnt(4)
    buffer_load_dwordx4 v8, s[36:39], s60 offen offset:2048 nt lds
    s_add_u32 s60, s60, 261120
    s_waitcnt vmcnt(4)
    buffer_load_dwordx4 v8, s[36:39], s60 offen offset:3072 nt lds
    s_add_u32 s60, s60, 265216
    v_lshrrev_b32 v148, 4, v1
    v_and_b32 v149, 15, v1
    v_mul_u32_u24 v9, 7168, v171
    v_add_u32 v9, v9, v172
    s_mul_i32 s63, s63, 57344
    s_add_u32 s63, s63, s62
    s_mov_b32 s64, s63
    s_cmp_lt_u32 s45, 56
    s_cselect_b32 s71, 1, 0
    s_cbranch_scc0 L_ld_kv
    s_mov_b32 s36, s16
    s_mov_b32 s37, s17
    s_mov_b32 s38, 0x700000
    s_mov_b32 s39, 0x20000
    s_add_u32 m0, s47, 8192
    s_waitcnt vmcnt(4)
    buffer_load_dwordx4 v9, s[36:39], s63 offen offset:0 nt lds
    s_add_u32 s63, s63, 228352
    s_waitcnt vmcnt(4)
    buffer_load_dwordx4 v9, s[36:39], s63 offen offset:1024 nt lds
    s_add_u32 s63, s63, 228352
    s_waitcnt vmcnt(4)
    buffer_load_dwordx4 v9, s[36:39], s63 offen offset:2048 nt lds
    s_add_u32 s63, s63, 228352
    s_waitcnt vmcnt(4)
    buffer_load_dwordx4 v9, s[36:39], s63 offen offset:3072 nt lds
    s_add_u32 s63, s63, 232448
    s_add_u32 m0, s47, 12288
    s_waitcnt vmcnt(4)
    v_mov_b32 v5, 2
    s_mov_b64 exec, 1
    ds_write_b32 v2, v5 offset:0
    s_mov_b64 exec, -1
    buffer_load_dwordx4 v9, s[36:39], s63 offen offset:0 nt lds
    s_add_u32 s63, s63, 228352
    s_waitcnt vmcnt(4)
    buffer_load_dwordx4 v9, s[36:39], s63 offen offset:1024 nt lds
    s_add_u32 s63, s63, 228352
    s_waitcnt vmcnt(4)
    buffer_load_dwordx4 v9, s[36:39], s63 offen offset:2048 nt lds
    s_add_u32 s63, s63, 228352
    s_waitcnt vmcnt(4)
    buffer_load_dwordx4 v9, s[36:39], s63 offen offset:3072 nt lds
    s_add_u32 s63, s63, 232448
    s_mov_b32 s36, s18
    s_mov_b32 s37, s19
    s_mov_b32 s38, 0x700000
    s_mov_b32 s39, 0x20000
    s_add_u32 m0, s47, 16384
    s_waitcnt vmcnt(4)
    buffer_load_dwordx4 v9, s[36:39], s64 offen offset:0 nt lds
    s_add_u32 s64, s64, 228352
    s_waitcnt vmcnt(4)
    buffer_load_dwordx4 v9, s[36:39], s64 offen offset:1024 nt lds
    s_add_u32 s64, s64, 228352
    s_waitcnt vmcnt(4)
    buffer_load_dwordx4 v9, s[36:39], s64 offen offset:2048 nt lds
    s_add_u32 s64, s64, 228352
    s_waitcnt vmcnt(4)
    buffer_load_dwordx4 v9, s[36:39], s64 offen offset:3072 nt lds
    s_add_u32 s64, s64, 232448
    s_add_u32 m0, s47, 20480
    s_waitcnt vmcnt(4)
    v_mov_b32 v5, 4
    s_mov_b64 exec, 1
    ds_write_b32 v2, v5 offset:0
    s_mov_b64 exec, -1
    buffer_load_dwordx4 v9, s[36:39], s64 offen offset:0 nt lds
    s_add_u32 s64, s64, 228352
    s_waitcnt vmcnt(4)
    buffer_load_dwordx4 v9, s[36:39], s64 offen offset:1024 nt lds
    s_add_u32 s64, s64, 228352
    s_waitcnt vmcnt(4)
    buffer_load_dwordx4 v9, s[36:39], s64 offen offset:2048 nt lds
    s_add_u32 s64, s64, 228352
    s_waitcnt vmcnt(4)
    buffer_load_dwordx4 v9, s[36:39], s64 offen offset:3072 nt lds
    s_add_u32 s64, s64, 232448
L_ld_kv:
    v_lshlrev_b32 v171, 1, v148
    v_xor_b32 v171, v171, v149
    v_lshlrev_b32 v171, 4, v171
    v_lshl_add_u32 v10, v148, 8, v171
    v_xor_b32 v11, 0x80, v10
    v_lshl_add_u32 v12, v148, 11, v171
    v_xor_b32 v13, 0x80, v12
    s_mov_b32 s28, s6
    s_mov_b32 s29, s7
    s_mov_b32 s30, 0x4000000
    s_mov_b32 s31, 0x20000
    s_lshl_b32 s50, s49, 5
    s_add_u32 s50, s50, s54
    s_lshl_b32 s50, s50, 18
    s_lshl_b32 s62, s44, 12
    s_add_u32 s50, s50, s62
    s_mov_b32 s51, 3
    s_and_b32 s55, s54, 7
    s_lshl_b32 s55, s55, 15
    s_mov_b32 s57, 6
    s_add_u32 s56, s47, 24576
    s_mov_b32 s60, 0x6000
    v_mov_b32 v3, 161856
    v_and_b32 v24, 3, v1
    v_lshlrev_b32 v24, 4, v24
    v_add_u32 v24, 161792, v24
L_ld_loop:
    ds_read_b32 v168, v3 offset:28
    ds_read_b32 v169, v24 offset:8
    v_mov_b32 v5, s51
    s_mov_b64 exec, 1
    ds_write_b32 v2, v5 offset:8
    s_mov_b64 exec, -1
    s_sub_u32 s53, s51, 3
L_pw_1:
    s_cmp_ge_i32 s52, s53
    s_cbranch_scc1 L_pk_2
    ds_read_b32 v5, v2 offset:4
    s_add_u32 s70, s70, 1
    s_cmp_gt_u32 s70, 0x400000
    s_cbranch_scc1 L_end
    s_waitcnt lgkmcnt(0)
    v_readfirstlane_b32 s52, v5
    s_branch L_pw_1
L_pk_2:
    s_add_u32 s51, s51, 1
    s_xor_b32 s64, s50, s55
    s_add_u32 s61, s64, 16384
    s_waitcnt lgkmcnt(0)
    v_readfirstlane_b32 s63, v168
    s_sub_u32 s62, s51, 1
    v_cmp_le_u32 vcc, s62, v169
    s_cmp_eq_u32 s63, 2
    s_cbranch_scc1 L_ld_v2
    s_and_b32 s62, vcc_lo, 15
    s_bcnt1_i32_b32 s62, s62
    s_cmp_ge_u32 s62, 3
    s_cbranch_scc1 L_ld_v1
    s_mov_b32 m0, s56
    s_waitcnt vmcnt(4)
    s_sub_u32 s62, s57, 1
    v_mov_b32 v5, s62
    s_mov_b64 exec, 1
    ds_write_b32 v2, v5 offset:0
    s_mov_b64 exec, -1
    buffer_load_dwordx4 v10, s[28:31], s64 offen offset:0 nt lds
    s_waitcnt vmcnt(4)
    buffer_load_dwordx4 v11, s[28:31], s64 offen offset:1024 nt lds
    s_waitcnt vmcnt(4)
    buffer_load_dwordx4 v10, s[28:31], s64 offen offset:2048 nt lds
    s_waitcnt vmcnt(4)
    buffer_load_dwordx4 v11, s[28:31], s64 offen offset:3072 nt lds
    s_add_u32 s57, s57, 1
    s_add_u32 m0, s56, 4096
    s_waitcnt vmcnt(4)
    s_sub_u32 s62, s57, 1
    v_mov_b32 v5, s62
    s_mov_b64 exec, 1
    ds_write_b32 v2, v5 offset:0
    s_mov_b64 exec, -1
    buffer_load_dwordx4 v10, s[28:31], s61 offen offset:0 nt lds
    s_waitcnt vmcnt(4)
    buffer_load_dwordx4 v11, s[28:31], s61 offen offset:1024 nt lds
    s_waitcnt vmcnt(4)
    buffer_load_dwordx4 v10, s[28:31], s61 offen offset:2048 nt lds
    s_waitcnt vmcnt(4)
    buffer_load_dwordx4 v11, s[28:31], s61 offen offset:3072 nt lds
    s_add_u32 s57, s57, 1
    s_branch L_ld_nx
L_ld_v1:
    s_mov_b32 m0, s56
    s_waitcnt vmcnt(5)
    buffer_load_dwordx4 v10, s[28:31], s64 offen offset:0 nt lds
    s_waitcnt vmcnt(5)
    s_sub_u32 s62, s57, 1
    v_mov_b32 v5, s62
    s_mov_b64 exec, 1
    ds_write_b32 v2, v5 offset:0
    s_mov_b64 exec, -1
    buffer_load_dwordx4 v11, s[28:31], s64 offen offset:1024 nt lds
    s_waitcnt vmcnt(5)
    buffer_load_dwordx4 v10, s[28:31], s64 offen offset:2048 nt lds
    s_waitcnt vmcnt(5)
    buffer_load_dwordx4 v11, s[28:31], s64 offen offset:3072 nt lds
    s_add_u32 s57, s57, 1
    s_add_u32 m0, s56, 4096
    s_waitcnt vmcnt(5)
    buffer_load_dwordx4 v10, s[28:31], s61 offen offset:0 nt lds
    s_waitcnt vmcnt(5)
    s_sub_u32 s62, s57, 1
    v_mov_b32 v5, s62
    s_mov_b64 exec, 1
    ds_write_b32 v2, v5 offset:0
    s_mov_b64 exec, -1
    buffer_load_dwordx4 v11, s[28:31], s61 offen offset:1024 nt lds
    s_waitcnt vmcnt(5)
    buffer_load_dwordx4 v10, s[28:31], s61 offen offset:2048 nt lds
    s_waitcnt vmcnt(5)
    buffer_load_dwordx4 v11, s[28:31], s61 offen offset:3072 nt lds
    s_add_u32 s57, s57, 1
    s_branch L_ld_nx
L_ld_v2:
    s_mov_b32 m0, s56
    s_waitcnt vmcnt(6)
    buffer_load_dwordx4 v10, s[28:31], s64 offen offset:0 nt lds
    s_waitcnt vmcnt(6)
    buffer_load_dwordx4 v11, s[28:31], s64 offen offset:1024 nt lds
    s_waitcnt vmcnt(6)
    s_sub_u32 s62, s57, 1
    v_mov_b32 v5, s62
    s_mov_b64 exec, 1
    ds_write_b32 v2, v5 offset:0
    s_mov_b64 exec, -1
    buffer_load_dwordx4 v10, s[28:31], s64 offen offset:2048 nt lds
    s_waitcnt vmcnt(6)
    buffer_load_dwordx4 v11, s[28:31], s64 offen offset:3072 nt lds
    s_add_u32 s57, s57, 1
    s_add_u32 m0, s56, 4096
    s_waitcnt vmcnt(6)
    buffer_load_dwordx4 v10, s[28:31], s61 offen offset:0 nt lds
    s_waitcnt vmcnt(6)
    buffer_load_dwordx4 v11, s[28:31], s61 offen offset:1024 nt lds
    s_waitcnt vmcnt(6)
    s_sub_u32 s62, s57, 1
    v_mov_b32 v5, s62
    s_mov_b64 exec, 1
    ds_write_b32 v2, v5 offset:0
    s_mov_b64 exec, -1
    buffer_load_dwordx4 v10, s[28:31], s61 offen offset:2048 nt lds
    s_waitcnt vmcnt(6)
    buffer_load_dwordx4 v11, s[28:31], s61 offen offset:3072 nt lds
    s_add_u32 s57, s57, 1
L_ld_nx:
    s_xor_b32 s56, s56, s60
    s_xor_b32 s60, s60, 0x4000
    s_add_u32 s50, s50, 32768
    s_sub_u32 s62, s50, 262144
    s_cmp_eq_u32 s51, 11
    s_cselect_b32 s28, s8, s28
    s_cselect_b32 s29, s9, s29
    s_cselect_b32 s50, s62, s50
    s_cmp_lt_u32 s51, 19
    s_cbranch_scc1 L_ld_loop
    s_lshr_b32 s69, s45, 3
    s_lshl_b32 s69, s69, 2
    s_add_u32 s69, s69, s46
    s_lshl_b32 s69, s69, 18
    s_lshl_b32 s62, s44, 16
    s_add_u32 s69, s69, s62
    s_lshl_b32 s62, s49, 8
    s_add_u32 s69, s69, s62
    s_mov_b32 s65, s69
    s_mov_b32 s36, s20
    s_mov_b32 s37, s21
    s_mov_b32 s38, 0x700000
    s_mov_b32 s39, 0x20000
    s_cmp_lg_u32 s71, 0
    s_cbranch_scc1 L_ld_wd
    s_mov_b32 s36, s12
    s_mov_b32 s37, s13
    s_mov_b32 s38, 0x800000
    s_mov_b32 s39, 0x20000
    s_add_u32 s51, s51, 1
    s_sub_u32 s53, s51, 3
L_pw_3:
    s_cmp_ge_i32 s52, s53
    s_cbranch_scc1 L_pk_4
    ds_read_b32 v5, v2 offset:4
    s_add_u32 s70, s70, 1
    s_cmp_gt_u32 s70, 0x400000
    s_cbranch_scc1 L_end
    s_waitcnt lgkmcnt(0)
    v_readfirstlane_b32 s52, v5
    s_branch L_pw_3
L_pk_4:
    s_add_u32 s51, s51, 1
    s_mov_b32 m0, s47
    s_waitcnt vmcnt(4)
    buffer_load_dwordx4 v12, s[36:39], s69 offen offset:0 nt lds
    s_add_u32 s69, s69, 7168
    s_waitcnt vmcnt(4)
    buffer_load_dwordx4 v13, s[36:39], s69 offen offset:1024 nt lds
    s_add_u32 s69, s69, 7168
    s_waitcnt vmcnt(4)
    buffer_load_dwordx4 v12, s[36:39], s69 offen offset:2048 nt lds
    s_add_u32 s69, s69, 7168
    s_waitcnt vmcnt(4)
    buffer_load_dwordx4 v13, s[36:39], s69 offen offset:3072 nt lds
    s_add_u32 s69, s69, 11264
    s_add_u32 s57, s57, 1
    s_waitcnt vmcnt(4)
    v_mov_b32 v5, 38
    s_mov_b64 exec, 1
    ds_write_b32 v2, v5 offset:0
    s_mov_b64 exec, -1
    s_add_u32 m0, s47, 4096
    s_waitcnt vmcnt(11)
    buffer_load_dwordx4 v12, s[36:39], s69 offen offset:0 nt lds
    s_add_u32 s69, s69, 7168
    s_waitcnt vmcnt(11)
    buffer_load_dwordx4 v13, s[36:39], s69 offen offset:1024 nt lds
    s_add_u32 s69, s69, 7168
    s_waitcnt vmcnt(11)
    buffer_load_dwordx4 v12, s[36:39], s69 offen offset:2048 nt lds
    s_add_u32 s69, s69, 7168
    s_waitcnt vmcnt(11)
    buffer_load_dwordx4 v13, s[36:39], s69 offen offset:3072 nt lds
    s_add_u32 s69, s69, 11264
    s_add_u32 s57, s57, 1
    s_branch L_ld_fin
L_ld_wd:
    s_sub_u32 s53, s51, 3
L_pw_5:
    s_cmp_ge_i32 s52, s53
    s_cbranch_scc1 L_pk_6
    ds_read_b32 v5, v2 offset:4
    s_add_u32 s70, s70, 1
    s_cmp_gt_u32 s70, 0x400000
    s_cbranch_scc1 L_end
    s_waitcnt lgkmcnt(0)
    v_readfirstlane_b32 s52, v5
    s_branch L_pw_5
L_pk_6:
    s_add_u32 s51, s51, 1
    s_mov_b32 m0, s56
    s_waitcnt vmcnt(4)
    buffer_load_dwordx4 v12, s[36:39], s65 offen offset:0 nt lds
    s_add_u32 s65, s65, 7168
    s_waitcnt vmcnt(4)
    buffer_load_dwordx4 v13, s[36:39], s65 offen offset:1024 nt lds
    s_add_u32 s65, s65, 7168
    s_waitcnt vmcnt(4)
    buffer_load_dwordx4 v12, s[36:39], s65 offen offset:2048 nt lds
    s_add_u32 s65, s65, 7168
    s_waitcnt vmcnt(4)
    buffer_load_dwordx4 v13, s[36:39], s65 offen offset:3072 nt lds
    s_add_u32 s65, s65, 11264
    s_waitcnt vmcnt(4)
    v_mov_b32 v5, 38
    s_mov_b64 exec, 1
    ds_write_b32 v2, v5 offset:0
    s_mov_b64 exec, -1
    s_mov_b32 s62, 0
L_pw_7:
    s_cmp_ge_i32 s62, 4
    s_cbranch_scc1 L_pk_8
    ds_read_b32 v5, v3 offset:20
    s_add_u32 s70, s70, 1
    s_cmp_gt_u32 s70, 0x400000
    s_cbranch_scc1 L_end
    s_waitcnt lgkmcnt(0)
    v_readfirstlane_b32 s62, v5
    s_branch L_pw_7
L_pk_8:
    s_add_u32 m0, s56, 4096
    s_waitcnt vmcnt(11)
    buffer_load_dwordx4 v12, s[36:39], s65 offen offset:0 nt lds
    s_add_u32 s65, s65, 7168
    s_waitcnt vmcnt(11)
    buffer_load_dwordx4 v13, s[36:39], s65 offen offset:1024 nt lds
    s_add_u32 s65, s65, 7168
    s_waitcnt vmcnt(11)
    buffer_load_dwordx4 v12, s[36:39], s65 offen offset:2048 nt lds
    s_add_u32 s65, s65, 7168
    s_waitcnt vmcnt(11)
    buffer_load_dwordx4 v13, s[36:39], s65 offen offset:3072 nt lds
    s_add_u32 s65, s65, 11264
    s_xor_b32 s56, s56, 0x6000
    s_mov_b32 s36, s12
    s_mov_b32 s37, s13
    s_mov_b32 s38, 0x800000
    s_mov_b32 s39, 0x20000
    s_sub_u32 s53, s51, 3
L_pw_9:
    s_cmp_ge_i32 s52, s53
    s_cbranch_scc1 L_pk_10
    ds_read_b32 v5, v2 offset:4
    s_add_u32 s70, s70, 1
    s_cmp_gt_u32 s70, 0x400000
    s_cbranch_scc1 L_end
    s_waitcnt lgkmcnt(0)
    v_readfirstlane_b32 s52, v5
    s_branch L_pw_9
L_pk_10:
    s_add_u32 s51, s51, 1
    s_mov_b32 m0, s56
    s_waitcnt vmcnt(11)
    buffer_load_dwordx4 v12, s[36:39], s69 offen offset:0 nt lds
    s_add_u32 s69, s69, 7168
    s_waitcnt vmcnt(11)
    buffer_load_dwordx4 v13, s[36:39], s69 offen offset:1024 nt lds
    s_add_u32 s69, s69, 7168
    s_waitcnt vmcnt(11)
    buffer_load_dwordx4 v12, s[36:39], s69 offen offset:2048 nt lds
    s_add_u32 s69, s69, 7168
    s_waitcnt vmcnt(11)
    buffer_load_dwordx4 v13, s[36:39], s69 offen offset:3072 nt lds
    s_add_u32 s69, s69, 11264
    s_add_u32 m0, s56, 4096
    s_waitcnt vmcnt(11)
    buffer_load_dwordx4 v12, s[36:39], s69 offen offset:0 nt lds
    s_add_u32 s69, s69, 7168
    s_waitcnt vmcnt(11)
    buffer_load_dwordx4 v13, s[36:39], s69 offen offset:1024 nt lds
    s_add_u32 s69, s69, 7168
    s_waitcnt vmcnt(11)
    buffer_load_dwordx4 v12, s[36:39], s69 offen offset:2048 nt lds
    s_add_u32 s69, s69, 7168
    s_waitcnt vmcnt(11)
    buffer_load_dwordx4 v13, s[36:39], s69 offen offset:3072 nt lds
    s_add_u32 s69, s69, 11264
    s_waitcnt vmcnt(8)
    v_mov_b32 v5, 40
    s_mov_b64 exec, 1
    ds_write_b32 v2, v5 offset:0
    s_mov_b64 exec, -1
L_ld_fin:
    s_waitcnt vmcnt(0)
    v_mov_b32 v5, 42
    s_mov_b64 exec, 1
    ds_write_b32 v2, v5 offset:0
    s_mov_b64 exec, -1
    s_waitcnt lgkmcnt(0)
    s_endpgm
L_consumer:
    v_mov_b32 v3, 161856
    v_mov_b32 v4, 1
    v_lshrrev_b32 v148, 4, v1
    v_and_b32 v149, 15, v1
    s_mov_b32 s70, 0
    s_mov_b32 s52, 0
    s_lshl_b32 s61, s44, 4
    s_add_u32 s61, s61, 161792
    v_mov_b32 v2, s61
    s_cmp_lt_u32 s45, 56
    s_cselect_b32 s71, 1, 0
    s_mov_b32 s40, s26
    s_mov_b32 s41, s27
    s_mov_b32 s42, 0x500000
    s_mov_b32 s43, 0x20000
    s_getreg_b32 s32, hwreg(HW_REG_XCC_ID)
    s_waitcnt vmcnt(0)
    v_lshlrev_b32 v200, 16, v184
    v_and_b32 v201, 0xffff0000, v184
    v_lshlrev_b32 v202, 16, v185
    v_and_b32 v203, 0xffff0000, v185
    v_lshlrev_b32 v204, 16, v186
    v_and_b32 v205, 0xffff0000, v186
    v_lshlrev_b32 v206, 16, v187
    v_and_b32 v207, 0xffff0000, v187
    v_lshlrev_b32 v208, 16, v188
    v_and_b32 v209, 0xffff0000, v188
    v_lshlrev_b32 v210, 16, v189
    v_and_b32 v211, 0xffff0000, v189
    v_lshlrev_b32 v212, 16, v190
    v_and_b32 v213, 0xffff0000, v190
    v_lshlrev_b32 v214, 16, v191
    v_and_b32 v215, 0xffff0000, v191
    v_lshlrev_b32 v216, 16, v192
    v_and_b32 v217, 0xffff0000, v192
    v_lshlrev_b32 v218, 16, v193
    v_and_b32 v219, 0xffff0000, v193
    v_lshlrev_b32 v220, 16, v194
    v_and_b32 v221, 0xffff0000, v194
    v_lshlrev_b32 v222, 16, v195
    v_and_b32 v223, 0xffff0000, v195
    v_lshlrev_b32 v224, 16, v196
    v_and_b32 v225, 0xffff0000, v196
    v_lshlrev_b32 v226, 16, v197
    v_and_b32 v227, 0xffff0000, v197
    v_lshlrev_b32 v228, 16, v198
    v_and_b32 v229, 0xffff0000, v198
    v_lshlrev_b32 v230, 16, v199
    v_and_b32 v231, 0xffff0000, v199
    v_pk_add_f32 v[232:233], v[200:201], v[202:203]
    v_pk_add_f32 v[234:235], v[204:205], v[206:207]
    v_pk_add_f32 v[232:233], v[232:233], v[208:209]
    v_pk_add_f32 v[234:235], v[234:235], v[210:211]
    v_pk_add_f32 v[232:233], v[232:233], v[212:213]
    v_pk_add_f32 v[234:235], v[234:235], v[214:215]
    v_pk_add_f32 v[232:233], v[232:233], v[216:217]
    v_pk_add_f32 v[234:235], v[234:235], v[218:219]
    v_pk_add_f32 v[232:233], v[232:233], v[220:221]
    v_pk_add_f32 v[234:235], v[234:235], v[222:223]
    v_pk_add_f32 v[232:233], v[232:233], v[224:225]
    v_pk_add_f32 v[234:235], v[234:235], v[226:227]
    v_pk_add_f32 v[232:233], v[232:233], v[228:229]
    v_pk_add_f32 v[234:235], v[234:235], v[230:231]
    v_pk_add_f32 v[232:233], v[232:233], v[234:235]
    v_add_f32 v232, v232, v233
    s_nop 1
    v_add_f32_dpp v232, v232, v232 quad_perm:[1,0,3,2] row_mask:0xf bank_mask:0xf
    s_nop 1
    v_add_f32_dpp v232, v232, v232 quad_perm:[2,3,0,1] row_mask:0xf bank_mask:0xf
    s_nop 1
    v_add_f32_dpp v232, v232, v232 row_half_mirror row_mask:0xf bank_mask:0xf
    s_nop 1
    v_add_f32_dpp v232, v232, v232 row_mirror row_mask:0xf bank_mask:0xf
    v_mov_b32 v233, v232
    s_nop 1
    v_permlane16_swap_b32 v232, v233
    s_nop 0
    v_add_f32 v232, v232, v233
    v_mul_f32 v236, 0xba800000, v232
    v_mov_b32 v237, v236
    v_pk_add_f32 v[238:239], v[200:201], v[236:237]
    v_pk_add_f32 v[244:245], v[202:203], v[236:237]
    v_pk_mul_f32 v[240:241], v[238:239], v[238:239]
    v_pk_mul_f32 v[242:243], v[244:245], v[244:245]
    v_pk_add_f32 v[238:239], v[204:205], v[236:237]
    v_pk_add_f32 v[244:245], v[206:207], v[236:237]
    v_pk_fma_f32 v[240:241], v[238:239], v[238:239], v[240:241]
    v_pk_fma_f32 v[242:243], v[244:245], v[244:245], v[242:243]
    v_pk_add_f32 v[238:239], v[208:209], v[236:237]
    v_pk_add_f32 v[244:245], v[210:211], v[236:237]
    v_pk_fma_f32 v[240:241], v[238:239], v[238:239], v[240:241]
    v_pk_fma_f32 v[242:243], v[244:245], v[244:245], v[242:243]
    v_pk_add_f32 v[238:239], v[212:213], v[236:237]
    v_pk_add_f32 v[244:245], v[214:215], v[236:237]
    v_pk_fma_f32 v[240:241], v[238:239], v[238:239], v[240:241]
    v_pk_fma_f32 v[242:243], v[244:245], v[244:245], v[242:243]
    v_pk_add_f32 v[238:239], v[216:217], v[236:237]
    v_pk_add_f32 v[244:245], v[218:219], v[236:237]
    v_pk_fma_f32 v[240:241], v[238:239], v[238:239], v[240:241]
    v_pk_fma_f32 v[242:243], v[244:245], v[244:245], v[242:243]
    v_pk_add_f32 v[238:239], v[220:221], v[236:237]
    v_pk_add_f32 v[244:245], v[222:223], v[236:237]
    v_pk_fma_f32 v[240:241], v[238:239], v[238:239], v[240:241]
    v_pk_fma_f32 v[242:243], v[244:245], v[244:245], v[242:243]
    v_pk_add_f32 v[238:239], v[224:225], v[236:237]
    v_pk_add_f32 v[244:245], v[226:227], v[236:237]
    v_pk_fma_f32 v[240:241], v[238:239], v[238:239], v[240:241]
    v_pk_fma_f32 v[242:243], v[244:245], v[244:245], v[242:243]
    v_pk_add_f32 v[238:239], v[228:229], v[236:237]
    v_pk_add_f32 v[244:245], v[230:231], v[236:237]
    v_pk_fma_f32 v[240:241], v[238:239], v[238:239], v[240:241]
    v_pk_fma_f32 v[242:243], v[244:245], v[244:245], v[242:243]
    v_pk_add_f32 v[240:241], v[240:241], v[242:243]
    v_add_f32 v240, v240, v241
    s_nop 1
    v_add_f32_dpp v240, v240, v240 quad_perm:[1,0,3,2] row_mask:0xf bank_mask:0xf
    s_nop 1
    v_add_f32_dpp v240, v240, v240 quad_perm:[2,3,0,1] row_mask:0xf bank_mask:0xf
    s_nop 1
    v_add_f32_dpp v240, v240, v240 row_half_mirror row_mask:0xf bank_mask:0xf
    s_nop 1
    v_add_f32_dpp v240, v240, v240 row_mirror row_mask:0xf bank_mask:0xf
    v_mov_b32 v241, v240
    s_nop 1
    v_permlane16_swap_b32 v240, v241
    s_nop 0
    v_add_f32 v240, v240, v241
    v_mul_f32 v240, 0x3a800000, v240
    v_cvt_pk_bf16_f32 v240, v240, v240
    v_lshlrev_b32 v240, 16, v240
    v_add_f32 v240, 0x3727c5ac, v240
    v_cvt_pk_bf16_f32 v240, v240, v240
    v_lshlrev_b32 v240, 16, v240
    v_sqrt_f32 v240, v240
    v_cvt_pk_bf16_f32 v236, v236, v236
    v_lshlrev_b32 v236, 16, v236
    v_cvt_pk_bf16_f32 v240, v240, v240
    v_lshlrev_b32 v240, 16, v240
    v_rcp_f32 v241, v240
    v_add_f32 v238, v200, v236
    v_add_f32 v239, v201, v236
    v_cvt_pk_bf16_f32 v244, v238, v239
    v_lshlrev_b32 v238, 16, v244
    v_and_b32 v239, 0xffff0000, v244
    v_mul_f32 v244, v238, v241
    v_mul_f32 v245, v239, v241
    v_fma_f32 v238, -v244, v240, v238
    v_fma_f32 v239, -v245, v240, v239
    v_fma_f32 v244, v238, v241, v244
    v_fma_f32 v245, v239, v241, v245
    v_cvt_pk_bf16_f32 v248, v244, v245
    v_add_f32 v238, v202, v236
    v_add_f32 v239, v203, v236
    v_cvt_pk_bf16_f32 v244, v238, v239
    v_lshlrev_b32 v238, 16, v244
    v_and_b32 v239, 0xffff0000, v244
    v_mul_f32 v244, v238, v241
    v_mul_f32 v245, v239, v241
    v_fma_f32 v238, -v244, v240, v238
    v_fma_f32 v239, -v245, v240, v239
    v_fma_f32 v244, v238, v241, v244
    v_fma_f32 v245, v239, v241, v245
    v_cvt_pk_bf16_f32 v249, v244, v245
    v_add_f32 v238, v204, v236
    v_add_f32 v239, v205, v236
    v_cvt_pk_bf16_f32 v244, v238, v239
    v_lshlrev_b32 v238, 16, v244
    v_and_b32 v239, 0xffff0000, v244
    v_mul_f32 v244, v238, v241
    v_mul_f32 v245, v239, v241
    v_fma_f32 v238, -v244, v240, v238
    v_fma_f32 v239, -v245, v240, v239
    v_fma_f32 v244, v238, v241, v244
    v_fma_f32 v245, v239, v241, v245
    v_cvt_pk_bf16_f32 v250, v244, v245
    v_add_f32 v238, v206, v236
    v_add_f32 v239, v207, v236
    v_cvt_pk_bf16_f32 v244, v238, v239
    v_lshlrev_b32 v238, 16, v244
    v_and_b32 v239, 0xffff0000, v244
    v_mul_f32 v244, v238, v241
    v_mul_f32 v245, v239, v241
    v_fma_f32 v238, -v244, v240, v238
    v_fma_f32 v239, -v245, v240, v239
    v_fma_f32 v244, v238, v241, v244
    v_fma_f32 v245, v239, v241, v245
    v_cvt_pk_bf16_f32 v251, v244, v245
    s_lshl_b32 s61, s44, 10
    s_add_u32 s61, s61, 131072
    v_lshl_add_u32 v171, v1, 4, s61
    ds_write_b128 v171, v[248:251]
    v_and_b32 v172, 1, v1
    v_lshlrev_b32 v172, 9, v172
    v_lshl_add_u32 v172, v148, 6, v172
    s_lshl_b32 s62, s44, 4
    s_add_u32 s61, s61, s62
    v_add_u32 v172, s61, v172
    v_lshrrev_b32 v173, 2, v149
    v_lshlrev_b32 v173, 7, v173
    v_lshl_add_u32 v173, v148, 10, v173
    v_and_b32 v174, 3, v1
    v_lshl_add_u32 v173, v174, 3, v173
    v_add_u32 v173, s47, v173
    ds_read_b128 v[72:75], v172 offset:0
    ds_read_b128 v[76:79], v172 offset:256
    s_lshl_b32 s61, s44, 9
    s_add_u32 s61, s61, 135168
    v_lshl_add_u32 v174, v149, 2, s61
    s_lshl_b32 s61, s44, 11
    s_add_u32 s61, s61, 135168
    v_lshl_add_u32 v175, v1, 3, s61
    v_lshlrev_b32 v226, 10, v148
    v_lshl_add_u32 v226, v149, 4, v226
    v_add_u32 v227, 0x40000, v226
    v_lshlrev_b32 v224, 4, v1
    v_add_u32 v225, 0x40000, v224
    v_lshlrev_b32 v228, 3, v149
    s_lshl_b32 s34, s45, 12
    s_lshl_b32 s62, s44, 18
    s_add_u32 s34, s34, s62
    s_add_u32 s34, s34, 32768
    s_lshl_b32 s62, s46, 8
    s_add_u32 s33, s34, s62
    s_lshl_b32 s62, s46, 10
    s_add_u32 s34, s34, s62
    s_lshl_b32 s35, s45, 8
    s_and_b32 s62, s46, 1
    s_lshl_b32 s62, s62, 7
    s_add_u32 s35, s35, s62
    s_lshr_b32 s62, s46, 1
    s_lshl_b32 s62, s62, 14
    s_add_u32 s35, s35, s62
    s_lshl_b32 s62, s44, 15
    s_add_u32 s35, s35, s62
    s_add_u32 s35, s35, 3145728
    s_waitcnt lgkmcnt(0)
    s_add_u32 s48, s48, 0x9e3779b1
    s_cmp_eq_u32 s71, 0
    s_cselect_b32 s61, 6, 2
    s_cselect_b32 s60, 3, 1
L_pw_11:
    s_cmp_ge_i32 s52, s61
    s_cbranch_scc1 L_pk_12
    ds_read_b32 v5, v2 offset:0
    s_add_u32 s70, s70, 1
    s_cmp_gt_u32 s70, 0x400000
    s_cbranch_scc1 L_end
    s_waitcnt lgkmcnt(0)
    v_readfirstlane_b32 s52, v5
    s_branch L_pw_11
L_pk_12:
    ds_read_b64_tr_b16 v[116:117], v173 offset:0
    ds_read_b64_tr_b16 v[118:119], v173 offset:512
    ds_read_b64_tr_b16 v[120:121], v173 offset:32
    ds_read_b64_tr_b16 v[122:123], v173 offset:544
    ds_read_b64_tr_b16 v[124:125], v173 offset:64
    ds_read_b64_tr_b16 v[126:127], v173 offset:576
    ds_read_b64_tr_b16 v[128:129], v173 offset:96
    ds_read_b64_tr_b16 v[130:131], v173 offset:608
    ds_read_b64_tr_b16 v[132:133], v173 offset:4096
    ds_read_b64_tr_b16 v[134:135], v173 offset:4608
    ds_read_b64_tr_b16 v[136:137], v173 offset:4128
    ds_read_b64_tr_b16 v[138:139], v173 offset:4640
    ds_read_b64_tr_b16 v[140:141], v173 offset:4160
    ds_read_b64_tr_b16 v[142:143], v173 offset:4672
    ds_read_b64_tr_b16 v[144:145], v173 offset:4192
    ds_read_b64_tr_b16 v[146:147], v173 offset:4704
    v_mov_b32 v5, s60
    s_mov_b64 exec, 1
    ds_write_b32 v2, v5 offset:4
    s_mov_b64 exec, -1
    s_waitcnt lgkmcnt(0)
    v_mfma_f32_16x16x32_bf16 v[88:91], v[72:75], v[116:119], 0
    v_mfma_f32_16x16x32_bf16 v[92:95], v[72:75], v[120:123], 0
    v_mfma_f32_16x16x32_bf16 v[96:99], v[72:75], v[124:127], 0
    v_mfma_f32_16x16x32_bf16 v[100:103], v[72:75], v[128:131], 0
    v_mfma_f32_16x16x32_bf16 v[88:91], v[76:79], v[132:135], v[88:91]
    v_mfma_f32_16x16x32_bf16 v[92:95], v[76:79], v[136:139], v[92:95]
    v_mfma_f32_16x16x32_bf16 v[96:99], v[76:79], v[140:143], v[96:99]
    v_mfma_f32_16x16x32_bf16 v[100:103], v[76:79], v[144:147], v[100:103]
    s_nop 4
    ds_write2_b32 v174, v88, v89 offset0:0 offset1:64
    ds_write2_b32 v174, v92, v93 offset0:16 offset1:80
    ds_write2_b32 v174, v96, v97 offset0:32 offset1:96
    ds_write2_b32 v174, v100, v101 offset0:48 offset1:112
    s_mov_b64 exec, 1
    ds_add_u32 v3, v4 offset:0
    s_mov_b64 exec, -1
    s_cmp_lg_u32 s44, 0
    s_cbranch_scc1 L_q_done
    s_mov_b32 s62, 0
L_pw_13:
    s_cmp_ge_i32 s62, 4
    s_cbranch_scc1 L_pk_14
    ds_read_b32 v5, v3 offset:0
    s_add_u32 s70, s70, 1
    s_cmp_gt_u32 s70, 0x400000
    s_cbranch_scc1 L_end
    s_waitcnt lgkmcnt(0)
    v_readfirstlane_b32 s62, v5
    s_branch L_pw_13
L_pk_14:
    ds_read2_b64 v[204:207], v175 offset0:0 offset1:64
    ds_read2_b64 v[208:211], v175 offset0:128 offset1:192
    s_waitcnt lgkmcnt(0)
    v_pk_add_f32 v[204:205], v[204:205], v[206:207]
    v_pk_add_f32 v[208:209], v[208:209], v[210:211]
    v_add_f32 v232, v204, v208
    v_add_f32 v234, v205, v209
    v_mov_b32 v233, s48
    v_mov_b32 v235, s32
    buffer_store_dwordx4 v[232:235], v226, s[40:43], s33 offen
L_q_done:
    s_mov_b32 s58, 0x3fb8aa3b
    s_mov_b32 s59, 0x3db504f3
    v_and_b32 v171, 7, v1
    v_lshlrev_b32 v171, 1, v171
    v_xor_b32 v171, v171, v148
    v_lshlrev_b32 v171, 4, v171
    v_lshl_add_u32 v171, v149, 8, v171
    s_add_u32 s61, s47, 24576
    v_add_u32 v8, s61, v171
    v_xor_b32 v9, 64, v8
    v_xor_b32 v10, 128, v8
    v_xor_b32 v11, 192, v8
    v_lshrrev_b32 v171, 2, v1
    v_and_b32 v172, 7, v171
    v_lshlrev_b32 v172, 5, v172
    v_lshl_add_u32 v172, v171, 8, v172
    v_and_b32 v176, 3, v1
    v_lshl_add_u32 v172, v176, 3, v172
    v_add_u32 v12, s61, v172
    v_xor_b32 v13, 32, v12
    v_xor_b32 v14, 64, v12
    v_xor_b32 v15, 96, v12
    v_xor_b32 v16, 128, v12
    v_xor_b32 v17, 160, v12
    v_xor_b32 v18, 192, v12
    v_xor_b32 v19, 224, v12
    v_mov_b64 v[36:37], 0
    v_mov_b64 v[38:39], 0
    v_mov_b64 v[40:41], 0
    v_mov_b64 v[42:43], 0
    v_mov_b64 v[44:45], 0
    v_mov_b64 v[46:47], 0
    v_mov_b64 v[48:49], 0
    v_mov_b64 v[50:51], 0
    v_mov_b64 v[52:53], 0
    v_mov_b64 v[54:55], 0
    v_mov_b64 v[56:57], 0
    v_mov_b64 v[58:59], 0
    v_mov_b64 v[60:61], 0
    v_mov_b64 v[62:63], 0
    v_mov_b64 v[64:65], 0
    v_mov_b64 v[66:67], 0
    v_and_b32 v255, 7, v1
    v_lshl_add_u32 v255, v148, 3, v255
    s_mul_i32 s62, s44, 4224
    s_add_u32 s62, s62, 144896
    v_lshl_add_u32 v255, v255, 4, s62
    s_mov_b32 s39, 0x6000
    v_mov_b32 v68, 0xff7fffff
    v_mov_b32 v69, 0
    s_cmp_lg_u32 s44, 2
    s_cbranch_scc1 L_noxid
    s_lshl_b32 s61, s49, 8
    s_lshl_b32 s62, s54, 3
    s_add_u32 s61, s61, s62
    v_mov_b32 v176, s32
    v_mov_b32 v177, s48
    v_mov_b32 v178, 4096
    s_mov_b64 exec, 1
    buffer_store_dwordx2 v[176:177], v178, s[40:43], s61 offen sc1
    s_mov_b64 exec, -1
L_noxid:
    v_and_b32 v150, 31, v1
    v_lshlrev_b32 v150, 3, v150
    s_lshl_b32 s36, s49, 8
    s_add_u32 s36, s36, 8192
    s_lshl_b32 s37, s54, 3
    s_add_u32 s37, s37, s36
    v_mov_b32 v7, s48
    v_mov_b32 v151, 0
    v_mov_b32 v244, 0
    v_mov_b32 v245, 0
    s_mov_b32 s57, 0
    s_cmp_eq_u32 s71, 0
    s_cbranch_scc1 L_g_skip
    v_add_u32 v174, 2048, v174
L_pw_15:
    s_cmp_ge_i32 s52, 4
    s_cbranch_scc1 L_pk_16
    ds_read_b32 v5, v2 offset:0
    s_add_u32 s70, s70, 1
    s_cmp_gt_u32 s70, 0x400000
    s_cbranch_scc1 L_end
    s_waitcnt lgkmcnt(0)
    v_readfirstlane_b32 s52, v5
    s_branch L_pw_15
L_pk_16:
    ds_read_b64_tr_b16 v[116:117], v173 offset:8192
    ds_read_b64_tr_b16 v[118:119], v173 offset:8704
    ds_read_b64_tr_b16 v[120:121], v173 offset:8224
    ds_read_b64_tr_b16 v[122:123], v173 offset:8736
    ds_read_b64_tr_b16 v[124:125], v173 offset:8256
    ds_read_b64_tr_b16 v[126:127], v173 offset:8768
    ds_read_b64_tr_b16 v[128:129], v173 offset:8288
    ds_read_b64_tr_b16 v[130:131], v173 offset:8800
    ds_read_b64_tr_b16 v[132:133], v173 offset:12288
    ds_read_b64_tr_b16 v[134:135], v173 offset:12800
    ds_read_b64_tr_b16 v[136:137], v173 offset:12320
    ds_read_b64_tr_b16 v[138:139], v173 offset:12832
    ds_read_b64_tr_b16 v[140:141], v173 offset:12352
    ds_read_b64_tr_b16 v[142:143], v173 offset:12864
    ds_read_b64_tr_b16 v[144:145], v173 offset:12384
    ds_read_b64_tr_b16 v[146:147], v173 offset:12896
    v_mov_b32 v5, 2
    s_mov_b64 exec, 1
    ds_write_b32 v2, v5 offset:4
    s_mov_b64 exec, -1
    s_waitcnt lgkmcnt(0)
    v_mfma_f32_16x16x32_bf16 v[88:91], v[72:75], v[116:119], 0
    v_mfma_f32_16x16x32_bf16 v[92:95], v[72:75], v[120:123], 0
    v_mfma_f32_16x16x32_bf16 v[96:99], v[72:75], v[124:127], 0
    v_mfma_f32_16x16x32_bf16 v[100:103], v[72:75], v[128:131], 0
    v_mfma_f32_16x16x32_bf16 v[88:91], v[76:79], v[132:135], v[88:91]
    v_mfma_f32_16x16x32_bf16 v[92:95], v[76:79], v[136:139], v[92:95]
    v_mfma_f32_16x16x32_bf16 v[96:99], v[76:79], v[140:143], v[96:99]
    v_mfma_f32_16x16x32_bf16 v[100:103], v[76:79], v[144:147], v[100:103]
    s_nop 4
    ds_write2_b32 v174, v88, v89 offset0:0 offset1:64
    ds_write2_b32 v174, v92, v93 offset0:16 offset1:80
    ds_write2_b32 v174, v96, v97 offset0:32 offset1:96
    ds_write2_b32 v174, v100, v101 offset0:48 offset1:112
    s_branch L_g_done
L_g_skip:
L_pw_17:
    s_cmp_ge_i32 s52, 8
    s_cbranch_scc1 L_pk_18
    ds_read_b32 v5, v2 offset:0
    s_add_u32 s70, s70, 1
    s_cmp_gt_u32 s70, 0x400000
    s_cbranch_scc1 L_end
    s_waitcnt lgkmcnt(0)
    v_readfirstlane_b32 s52, v5
    s_branch L_pw_17
L_pk_18:
L_g_done:
    s_cmp_lg_u32 s44, 0
    s_cbranch_scc1 L_qa_done
    s_mov_b32 s62, 0
L_qa_try:
    buffer_load_dwordx4 v[196:199], v224, s[40:43], s34 offen sc1
    s_add_u32 s70, s70, 1
    s_cmp_gt_u32 s70, 0x400000
    s_cbranch_scc1 L_end
    s_waitcnt vmcnt(0)
    v_cmp_ne_u32 vcc, s48, v197
    s_cbranch_vccz L_qa_ok
    s_add_u32 s62, s62, 1
    s_cmp_lg_u32 s62, 16
    s_cbranch_scc1 L_qa_try
    buffer_store_dwordx4 v[232:235], v226, s[40:43], s33 offen sc1
    s_branch L_qa_try
L_qa_ok:
    v_cmp_ne_u32 vcc, s32, v199
    s_cbranch_vccz L_qa_go
    buffer_store_dwordx4 v[232:235], v226, s[40:43], s33 offen sc1
L_qa_go:
    v_mov_b32 v204, v196
    v_mov_b32 v205, v198
    s_nop 1
    v_permlane16_swap_b32 v196, v204
    v_permlane16_swap_b32 v198, v205
    v_add_f32 v196, v196, v204
    v_add_f32 v198, v198, v205
    v_mov_b32 v204, v196
    v_mov_b32 v205, v198
    s_nop 1
    v_permlane32_swap_b32 v196, v204
    v_permlane32_swap_b32 v198, v205
    v_add_f32 v196, v196, v204
    v_add_f32 v198, v198, v205
    v_cvt_pk_bf16_f32 v196, v196, v198
    s_mov_b64 exec, 0xffff
    buffer_store_dwordx2 v[196:197], v228, s[40:43], s35 offen sc1
    s_mov_b64 exec, -1
L_qa_done:
    s_cmp_eq_u32 s71, 0
    s_cbranch_scc1 L_h_done
    v_add_u32 v174, 2048, v174
L_pw_19:
    s_cmp_ge_i32 s52, 6
    s_cbranch_scc1 L_pk_20
    ds_read_b32 v5, v2 offset:0
    s_add_u32 s70, s70, 1
    s_cmp_gt_u32 s70, 0x400000
    s_cbranch_scc1 L_end
    s_waitcnt lgkmcnt(0)
    v_readfirstlane_b32 s52, v5
    s_branch L_pw_19
L_pk_20:
    ds_read_b64_tr_b16 v[116:117], v173 offset:16384
    ds_read_b64_tr_b16 v[118:119], v173 offset:16896
    ds_read_b64_tr_b16 v[120:121], v173 offset:16416
    ds_read_b64_tr_b16 v[122:123], v173 offset:16928
    ds_read_b64_tr_b16 v[124:125], v173 offset:16448
    ds_read_b64_tr_b16 v[126:127], v173 offset:16960
    ds_read_b64_tr_b16 v[128:129], v173 offset:16480
    ds_read_b64_tr_b16 v[130:131], v173 offset:16992
    ds_read_b64_tr_b16 v[132:133], v173 offset:20480
    ds_read_b64_tr_b16 v[134:135], v173 offset:20992
    ds_read_b64_tr_b16 v[136:137], v173 offset:20512
    ds_read_b64_tr_b16 v[138:139], v173 offset:21024
    ds_read_b64_tr_b16 v[140:141], v173 offset:20544
    ds_read_b64_tr_b16 v[142:143], v173 offset:21056
    ds_read_b64_tr_b16 v[144:145], v173 offset:20576
    ds_read_b64_tr_b16 v[146:147], v173 offset:21088
    v_mov_b32 v5, 3
    s_mov_b64 exec, 1
    ds_write_b32 v2, v5 offset:4
    s_mov_b64 exec, -1
    s_waitcnt lgkmcnt(0)
    v_mfma_f32_16x16x32_bf16 v[88:91], v[72:75], v[116:119], 0
    v_mfma_f32_16x16x32_bf16 v[92:95], v[72:75], v[120:123], 0
    v_mfma_f32_16x16x32_bf16 v[96:99], v[72:75], v[124:127], 0
    v_mfma_f32_16x16x32_bf16 v[100:103], v[72:75], v[128:131], 0
    v_mfma_f32_16x16x32_bf16 v[88:91], v[76:79], v[132:135], v[88:91]
    v_mfma_f32_16x16x32_bf16 v[92:95], v[76:79], v[136:139], v[92:95]
    v_mfma_f32_16x16x32_bf16 v[96:99], v[76:79], v[140:143], v[96:99]
    v_mfma_f32_16x16x32_bf16 v[100:103], v[76:79], v[144:147], v[100:103]
    s_nop 4
    ds_write2_b32 v174, v88, v89 offset0:0 offset1:64
    ds_write2_b32 v174, v92, v93 offset0:16 offset1:80
    ds_write2_b32 v174, v96, v97 offset0:32 offset1:96
    ds_write2_b32 v174, v100, v101 offset0:48 offset1:112
    s_mov_b64 exec, 1
    ds_add_u32 v3, v4 offset:4
    s_mov_b64 exec, -1
    s_cmp_lg_u32 s44, 1
    s_cbranch_scc1 L_h_done
    s_mov_b32 s62, 0
L_pw_21:
    s_cmp_ge_i32 s62, 4
    s_cbranch_scc1 L_pk_22
    ds_read_b32 v5, v3 offset:4
    s_add_u32 s70, s70, 1
    s_cmp_gt_u32 s70, 0x400000
    s_cbranch_scc1 L_end
    s_waitcnt lgkmcnt(0)
    v_readfirstlane_b32 s62, v5
    s_branch L_pw_21
L_pk_22:
    ds_read2_b64 v[204:207], v175 offset0:0 offset1:64
    ds_read2_b64 v[208:211], v175 offset0:128 offset1:192
    v_add_u32 v175, 2048, v175
    ds_read2_b64 v[212:215], v175 offset0:0 offset1:64
    ds_read2_b64 v[216:219], v175 offset0:128 offset1:192
    s_waitcnt lgkmcnt(0)
    v_pk_add_f32 v[204:205], v[204:205], v[206:207]
    v_pk_add_f32 v[208:209], v[208:209], v[210:211]
    v_add_f32 v232, v204, v208
    v_add_f32 v234, v205, v209
    v_mov_b32 v233, s48
    v_mov_b32 v235, s32
    v_pk_add_f32 v[212:213], v[212:213], v[214:215]
    v_pk_add_f32 v[216:217], v[216:217], v[218:219]
    v_add_f32 v236, v212, v216
    v_add_f32 v238, v213, v217
    v_mov_b32 v237, s48
    v_mov_b32 v239, s32
    buffer_store_dwordx4 v[232:235], v226, s[40:43], s33 offen
    buffer_store_dwordx4 v[236:239], v227, s[40:43], s33 offen
    s_mov_b32 s57, 4
L_h_done:
    s_mov_b32 s53, 6
    s_mov_b32 s51, 3
    s_mov_b32 s55, 0
    s_branch L_loop
L_hcol:
    s_mov_b32 s62, 0
L_ha_try:
    buffer_load_dwordx4 v[196:199], v224, s[40:43], s34 offen sc1
    buffer_load_dwordx4 v[200:203], v225, s[40:43], s34 offen sc1
    s_add_u32 s70, s70, 1
    s_cmp_gt_u32 s70, 0x400000
    s_cbranch_scc1 L_end
    s_waitcnt vmcnt(0)
    v_xor_b32 v204, s48, v197
    v_xor_b32 v205, s48, v201
    v_or_b32 v204, v204, v205
    v_cmp_ne_u32 vcc, 0, v204
    s_cbranch_vccz L_ha_ok
    s_add_u32 s62, s62, 1
    s_cmp_lg_u32 s62, 16
    s_cbranch_scc1 L_ha_try
    buffer_store_dwordx4 v[232:235], v226, s[40:43], s33 offen sc1
    buffer_store_dwordx4 v[236:239], v227, s[40:43], s33 offen sc1
    s_branch L_ha_try
L_ha_ok:
    v_cmp_ne_u32 vcc, s32, v199
    s_cbranch_vccz L_ha_go
    buffer_store_dwordx4 v[232:235], v226, s[40:43], s33 offen sc1
    buffer_store_dwordx4 v[236:239], v227, s[40:43], s33 offen sc1
L_ha_go:
    v_mov_b32 v204, v196
    v_mov_b32 v205, v198
    v_mov_b32 v206, v200
    v_mov_b32 v207, v202
    s_nop 1
    v_permlane16_swap_b32 v196, v204
    v_permlane16_swap_b32 v198, v205
    v_permlane16_swap_b32 v200, v206
    v_permlane16_swap_b32 v202, v207
    v_add_f32 v196, v196, v204
    v_add_f32 v198, v198, v205
    v_add_f32 v200, v200, v206
    v_add_f32 v202, v202, v207
    v_mov_b32 v204, v196
    v_mov_b32 v205, v198
    v_mov_b32 v206, v200
    v_mov_b32 v207, v202
    s_nop 1
    v_permlane32_swap_b32 v196, v204
    v_permlane32_swap_b32 v198, v205
    v_permlane32_swap_b32 v200, v206
    v_permlane32_swap_b32 v202, v207
    v_add_f32 v196, v196, v204
    v_add_f32 v198, v198, v205
    v_add_f32 v200, v200, v206
    v_add_f32 v202, v202, v207
    v_cvt_pk_bf16_f32 v208, v196, v198
    v_cvt_pk_bf16_f32 v209, v200, v202
    s_mov_b32 s62, 0xbdd2d3e8
    v_mov_b32 v212, 0xc0135761
    v_lshlrev_b32 v204, 16, v208
    v_and_b32 v205, 0xffff0000, v208
    v_lshlrev_b32 v206, 16, v209
    v_and_b32 v207, 0xffff0000, v209
    v_mul_f32 v208, v204, v204
    v_mul_f32 v209, v205, v205
    v_fma_f32 v208, v208, s62, v212
    v_fma_f32 v209, v209, s62, v212
    v_mul_f32 v208, v208, v204
    v_mul_f32 v209, v209, v205
    v_exp_f32 v208, v208
    v_exp_f32 v209, v209
    s_nop 0
    v_add_f32 v208, 1.0, v208
    v_add_f32 v209, 1.0, v209
    v_rcp_f32 v208, v208
    v_rcp_f32 v209, v209
    s_nop 0
    v_mul_f32 v208, v208, v204
    v_mul_f32 v209, v209, v205
    v_cvt_pk_bf16_f32 v210, v208, v209
    v_lshlrev_b32 v208, 16, v210
    v_and_b32 v209, 0xffff0000, v210
    v_mul_f32 v208, v208, v206
    v_mul_f32 v209, v209, v207
    v_cvt_pk_bf16_f32 v196, v208, v209
    s_mov_b64 exec, 0xffff
    buffer_store_dwordx2 v[196:197], v228, s[40:43], s35 offen sc1
    s_mov_b64 exec, -1
    s_branch L_knext
L_qget:
    v_lshlrev_b32 v181, 4, v1
    s_lshl_b32 s65, s49, 12
    s_lshl_b32 s62, s44, 10
    s_add_u32 s65, s65, s62
    s_add_u32 s65, s65, 3145728
    s_mul_i32 s61, s44, 544
    s_add_u32 s61, s61, 141312
    v_lshrrev_b32 v171, 5, v1
    v_lshlrev_b32 v171, 4, v171
    v_lshl_add_u32 v171, v1, 3, v171
    v_add_u32 v171, s61, v171
    v_and_b32 v172, 7, v1
    v_mul_u32_u24 v172, 272, v172
    v_lshl_add_u32 v172, v148, 4, v172
    v_add_u32 v172, 141312, v172
    s_cmp_eq_u32 s71, 0
    s_cselect_b32 s61, 10, 8
L_pw_23:
    s_cmp_ge_i32 s52, s61
    s_cbranch_scc1 L_pk_24
    ds_read_b32 v5, v2 offset:0
    s_add_u32 s70, s70, 1
    s_cmp_gt_u32 s70, 0x400000
    s_cbranch_scc1 L_end
    s_waitcnt lgkmcnt(0)
    v_readfirstlane_b32 s52, v5
    s_branch L_pw_23
L_pk_24:
L_q_try:
    buffer_load_dwordx4 v[184:187], v181, s[40:43], s65 offen sc1
    s_add_u32 s70, s70, 1
    s_cmp_gt_u32 s70, 0x400000
    s_cbranch_scc1 L_end
    s_waitcnt vmcnt(0)
    v_xor_b32 v173, s48, v185
    v_xor_b32 v174, s48, v187
    v_or_b32 v173, v173, v174
    v_cmp_ne_u32 vcc, 0, v173
    s_cbranch_vccnz L_q_try
    ds_write2_b32 v171, v184, v186 offset0:0 offset1:1
    s_mov_b64 exec, 1
    ds_add_u32 v3, v4 offset:8
    s_mov_b64 exec, -1
    s_mov_b32 s62, 0
L_pw_25:
    s_cmp_ge_i32 s62, 4
    s_cbranch_scc1 L_pk_26
    ds_read_b32 v5, v3 offset:8
    s_add_u32 s70, s70, 1
    s_cmp_gt_u32 s70, 0x400000
    s_cbranch_scc1 L_end
    s_waitcnt lgkmcnt(0)
    v_readfirstlane_b32 s62, v5
    s_branch L_pw_25
L_pk_26:
    ds_read_b128 v[20:23], v172 offset:0
    ds_read_b128 v[24:27], v172 offset:64
    ds_read_b128 v[28:31], v172 offset:128
    ds_read_b128 v[32:35], v172 offset:192
    s_branch L_qk
L_loop:
    s_add_u32 s53, s53, 2
    s_add_u32 s51, s51, 1
L_pw_27:
    s_cmp_ge_i32 s52, s53
    s_cbranch_scc1 L_pk_28
    ds_read_b32 v5, v2 offset:0
    s_add_u32 s70, s70, 1
    s_cmp_gt_u32 s70, 0x400000
    s_cbranch_scc1 L_end
    s_waitcnt lgkmcnt(0)
    v_readfirstlane_b32 s52, v5
    s_branch L_pw_27
L_pk_28:
    ds_read_b128 v[72:75], v8 offset:0
    ds_read_b128 v[76:79], v9 offset:0
    ds_read_b128 v[80:83], v10 offset:0
    ds_read_b128 v[84:87], v11 offset:0
    ds_read_b128 v[88:91], v8 offset:4096
    ds_read_b128 v[92:95], v9 offset:4096
    ds_read_b128 v[96:99], v10 offset:4096
    ds_read_b128 v[100:103], v11 offset:4096
    v_mov_b32 v5, s51
    s_mov_b64 exec, 1
    ds_write_b32 v2, v5 offset:4
    s_mov_b64 exec, -1
    v_xor_b32 v8, s39, v8
    v_xor_b32 v9, s39, v9
    v_xor_b32 v10, s39, v10
    v_xor_b32 v11, s39, v11
    s_xor_b32 s39, s39, 0x4000
    s_cmp_lg_u32 s44, 2
    s_cbranch_scc1 L_nb_k
    s_waitcnt vmcnt(0)
    s_sub_u32 s62, s51, 1
    v_cmp_eq_u32 vcc, s48, v245
    v_cmp_le_u32 s[66:67], s62, v244
    v_mov_b32 v6, s51
    s_mov_b64 exec, 1
    buffer_store_dwordx2 v[6:7], v151, s[40:43], s37 offen
    s_mov_b64 exec, -1
    buffer_load_dwordx2 v[244:245], v150, s[40:43], s36 offen sc1
    s_nop 1
    s_and_b32 s62, vcc_lo, s66
    s_bcnt1_i32_b32 s62, s62
    s_cmp_ge_u32 s62, 8
    s_cselect_b32 s66, 1, 0
    s_cmp_ge_u32 s62, 24
    s_cselect_b32 s66, 2, s66
    v_mov_b32 v5, s66
    s_mov_b64 exec, 1
    ds_write_b32 v3, v5 offset:28
    s_mov_b64 exec, -1
L_nb_k:
    s_add_u32 s55, s55, 1
    s_cmp_eq_u32 s55, 1
    s_cbranch_scc1 L_qget
L_qk:
    s_waitcnt lgkmcnt(0)
    v_mfma_f32_16x16x32_bf16 v[104:107], v[72:75], v[20:23], 0
    v_mfma_f32_16x16x32_bf16 v[108:111], v[88:91], v[20:23], 0
    v_mfma_f32_16x16x32_bf16 v[104:107], v[76:79], v[24:27], v[104:107]
    v_mfma_f32_16x16x32_bf16 v[108:111], v[92:95], v[24:27], v[108:111]
    v_mfma_f32_16x16x32_bf16 v[104:107], v[80:83], v[28:31], v[104:107]
    v_mfma_f32_16x16x32_bf16 v[108:111], v[96:99], v[28:31], v[108:111]
    v_mfma_f32_16x16x32_bf16 v[104:107], v[84:87], v[32:35], v[104:107]
    v_mfma_f32_16x16x32_bf16 v[108:111], v[100:103], v[32:35], v[108:111]
    s_nop 7
    v_cvt_pk_bf16_f32 v168, v104, v105
    v_cvt_pk_bf16_f32 v169, v106, v107
    v_cvt_pk_bf16_f32 v170, v108, v109
    v_cvt_pk_bf16_f32 v171, v110, v111
    v_lshlrev_b32 v104, 16, v168
    v_and_b32 v105, 0xffff0000, v168
    v_lshlrev_b32 v106, 16, v169
    v_and_b32 v107, 0xffff0000, v169
    v_lshlrev_b32 v108, 16, v170
    v_and_b32 v109, 0xffff0000, v170
    v_lshlrev_b32 v110, 16, v171
    v_and_b32 v111, 0xffff0000, v171
    v_mul_f32 v104, s59, v104
    v_mul_f32 v105, s59, v105
    v_mul_f32 v106, s59, v106
    v_mul_f32 v107, s59, v107
    v_mul_f32 v108, s59, v108
    v_mul_f32 v109, s59, v109
    v_mul_f32 v110, s59, v110
    v_mul_f32 v111, s59, v111
    v_cvt_pk_bf16_f32 v112, v104, v105
    v_cvt_pk_bf16_f32 v113, v106, v107
    v_cvt_pk_bf16_f32 v114, v108, v109
    v_cvt_pk_bf16_f32 v115, v110, v111
    v_max3_f32 v68, v68, v104, v105
    v_max3_f32 v168, v106, v107, v108
    ds_write_b128 v255, v[112:115]
    v_max3_f32 v68, v68, v109, v110
    v_add_u32 v255, 512, v255
    v_max3_f32 v68, v68, v168, v111
    s_cmp_eq_u32 s55, s57
    s_cbranch_scc1 L_hcol
L_knext:
    s_cmp_lt_u32 s55, 8
    s_cbranch_scc1 L_loop
    v_mov_b32 v168, v68
    s_nop 1
    v_permlane16_swap_b32 v68, v168
    s_nop 0
    v_max_f32 v68, v68, v168
    v_mov_b32 v168, v68
    s_nop 1
    v_permlane32_swap_b32 v68, v168
    s_nop 0
    v_max_f32 v68, v68, v168
    v_cvt_pk_bf16_f32 v68, v68, v68
    v_lshlrev_b32 v68, 16, v68
    v_mul_f32 v68, s58, v68
    v_add_u32 v255, -4096, v255
    s_mov_b32 s55, 0
L_vloop:
    ds_read_b128 v[168:171], v255
    v_add_u32 v255, 512, v255
    s_add_u32 s55, s55, 1
    s_add_u32 s53, s53, 2
    s_add_u32 s51, s51, 1
    s_waitcnt lgkmcnt(0)
    v_lshlrev_b32 v104, 16, v168
    v_and_b32 v105, 0xffff0000, v168
    v_lshlrev_b32 v106, 16, v169
    v_and_b32 v107, 0xffff0000, v169
    v_lshlrev_b32 v108, 16, v170
    v_and_b32 v109, 0xffff0000, v170
    v_lshlrev_b32 v110, 16, v171
    v_and_b32 v111, 0xffff0000, v171
    v_fma_f32 v104, v104, s58, -v68
    v_fma_f32 v105, v105, s58, -v68
    v_fma_f32 v106, v106, s58, -v68
    v_fma_f32 v107, v107, s58, -v68
    v_fma_f32 v108, v108, s58, -v68
    v_fma_f32 v109, v109, s58, -v68
    v_fma_f32 v110, v110, s58, -v68
    v_fma_f32 v111, v111, s58, -v68
    v_exp_f32 v104, v104
    v_exp_f32 v105, v105
    v_exp_f32 v106, v106
    v_exp_f32 v107, v107
    v_exp_f32 v108, v108
    v_exp_f32 v109, v109
    v_exp_f32 v110, v110
    v_exp_f32 v111, v111
    s_nop 0
    v_cvt_pk_bf16_f32 v112, v104, v105
    v_cvt_pk_bf16_f32 v113, v106, v107
    v_cvt_pk_bf16_f32 v114, v108, v109
    v_cvt_pk_bf16_f32 v115, v110, v111
    v_pk_add_f32 v[104:105], v[104:105], v[106:107]
    v_pk_add_f32 v[108:109], v[108:109], v[110:111]
    v_pk_add_f32 v[104:105], v[104:105], v[108:109]
    v_add_f32 v69, v69, v104
    v_add_f32 v69, v69, v105
    s_cmp_eq_u32 s55, 3
    s_cbranch_scc1 L_mid
    s_cmp_eq_u32 s55, 8
    s_cbranch_scc1 L_last
L_pv:
L_pw_29:
    s_cmp_ge_i32 s52, s53
    s_cbranch_scc1 L_pk_30
    ds_read_b32 v5, v2 offset:0
    s_add_u32 s70, s70, 1
    s_cmp_gt_u32 s70, 0x400000
    s_cbranch_scc1 L_end
    s_waitcnt lgkmcnt(0)
    v_readfirstlane_b32 s52, v5
    s_branch L_pw_29
L_pk_30:
    ds_read_b64_tr_b16 v[116:117], v12
    ds_read_b64_tr_b16 v[118:119], v12 offset:4096
    ds_read_b64_tr_b16 v[120:121], v13
    ds_read_b64_tr_b16 v[122:123], v13 offset:4096
    ds_read_b64_tr_b16 v[124:125], v14
    ds_read_b64_tr_b16 v[126:127], v14 offset:4096
    ds_read_b64_tr_b16 v[128:129], v15
    ds_read_b64_tr_b16 v[130:131], v15 offset:4096
    ds_read_b64_tr_b16 v[132:133], v16
    ds_read_b64_tr_b16 v[134:135], v16 offset:4096
    ds_read_b64_tr_b16 v[136:137], v17
    ds_read_b64_tr_b16 v[138:139], v17 offset:4096
    ds_read_b64_tr_b16 v[140:141], v18
    ds_read_b64_tr_b16 v[142:143], v18 offset:4096
    ds_read_b64_tr_b16 v[144:145], v19
    ds_read_b64_tr_b16 v[146:147], v19 offset:4096
    v_mov_b32 v5, s51
    s_mov_b64 exec, 1
    ds_write_b32 v2, v5 offset:4
    s_mov_b64 exec, -1
    v_xor_b32 v12, s39, v12
    v_xor_b32 v13, s39, v13
    v_xor_b32 v14, s39, v14
    v_xor_b32 v15, s39, v15
    v_xor_b32 v16, s39, v16
    v_xor_b32 v17, s39, v17
    v_xor_b32 v18, s39, v18
    v_xor_b32 v19, s39, v19
    s_xor_b32 s39, s39, 0x4000
    s_cmp_lg_u32 s44, 2
    s_cbranch_scc1 L_nb_v
    s_waitcnt vmcnt(0)
    s_sub_u32 s62, s51, 1
    v_cmp_eq_u32 vcc, s48, v245
    v_cmp_le_u32 s[66:67], s62, v244
    v_mov_b32 v6, s51
    s_mov_b64 exec, 1
    buffer_store_dwordx2 v[6:7], v151, s[40:43], s37 offen
    s_mov_b64 exec, -1
    buffer_load_dwordx2 v[244:245], v150, s[40:43], s36 offen sc1
    s_nop 1
    s_and_b32 s62, vcc_lo, s66
    s_bcnt1_i32_b32 s62, s62
    s_cmp_ge_u32 s62, 8
    s_cselect_b32 s66, 1, 0
    s_cmp_ge_u32 s62, 24
    s_cselect_b32 s66, 2, s66
    v_mov_b32 v5, s66
    s_mov_b64 exec, 1
    ds_write_b32 v3, v5 offset:28
    s_mov_b64 exec, -1
L_nb_v:
    s_waitcnt lgkmcnt(0)
    v_mfma_f32_16x16x32_bf16 v[36:39], v[116:119], v[112:115], v[36:39]
    v_mfma_f32_16x16x32_bf16 v[40:43], v[120:123], v[112:115], v[40:43]
    v_mfma_f32_16x16x32_bf16 v[44:47], v[124:127], v[112:115], v[44:47]
    v_mfma_f32_16x16x32_bf16 v[48:51], v[128:131], v[112:115], v[48:51]
    v_mfma_f32_16x16x32_bf16 v[52:55], v[132:135], v[112:115], v[52:55]
    v_mfma_f32_16x16x32_bf16 v[56:59], v[136:139], v[112:115], v[56:59]
    v_mfma_f32_16x16x32_bf16 v[60:63], v[140:143], v[112:115], v[60:63]
    v_mfma_f32_16x16x32_bf16 v[64:67], v[144:147], v[112:115], v[64:67]
    s_cmp_lt_u32 s55, 8
    s_cbranch_scc1 L_vloop
    s_branch L_loop_done
L_mid:
    v_and_b32 v169, 1, v1
    v_lshlrev_b32 v169, 14, v169
    v_lshl_add_u32 v169, v148, 4, v169
    s_lshr_b32 s38, s45, 3
    s_lshl_b32 s38, s38, 2
    s_add_u32 s38, s38, s46
    s_min_u32 s75, s38, 27
    s_lshl_b32 s75, s75, 9
    s_add_u32 s75, s75, 3178496
    v_and_b32 v170, 31, v1
    v_lshlrev_b32 v170, 3, v170
    s_lshl_b32 s65, s49, 8
    s_add_u32 s65, s65, 4096
    v_lshlrev_b32 v240, 4, v1
    v_and_b32 v178, 7, v1
    s_lshl_b32 s63, s46, 2
    s_add_u32 s63, s63, s44
    s_lshl_b32 s63, s63, 1
    s_lshl_b32 s73, s49, 5
    s_add_u32 s73, s73, s63
    s_lshl_b32 s72, s73, 7
    s_add_u32 s72, s72, 3211264
    s_lshl_b32 s73, s73, 12
    s_add_u32 s73, s73, 819200
    s_lshl_b32 s74, s49, 4
    s_and_b32 s62, s54, 15
    s_add_u32 s74, s74, s62
    s_lshl_b32 s62, s74, 4
    v_lshl_add_u32 v242, v178, 1, s62
    global_load_ushort v70, v242, s[4:5]
    global_load_ushort v71, v242, s[4:5] offset:2048
    s_lshl_b32 s74, s74, 12
    s_add_u32 s74, s74, 1867776
L_h_try:
    buffer_load_dwordx4 v[208:211], v169, s[40:43], s75 offen offset:0 sc1
    buffer_load_dwordx4 v[212:215], v169, s[40:43], s75 offen offset:64 sc1
    buffer_load_dwordx4 v[216:219], v169, s[40:43], s75 offen offset:128 sc1
    buffer_load_dwordx4 v[220:223], v169, s[40:43], s75 offen offset:192 sc1
    buffer_load_dwordx4 v[224:227], v169, s[40:43], s75 offen offset:256 sc1
    buffer_load_dwordx4 v[228:231], v169, s[40:43], s75 offen offset:320 sc1
    buffer_load_dwordx4 v[232:235], v169, s[40:43], s75 offen offset:384 sc1
    buffer_load_dwordx4 v[236:239], v169, s[40:43], s75 offen offset:448 sc1
    buffer_load_dwordx2 v[204:205], v170, s[40:43], s65 offen sc1
    s_add_u32 s70, s70, 1
    s_cmp_gt_u32 s70, 0x400000
    s_cbranch_scc1 L_end
    v_mul_u32_u24 v172, 528, v178
    v_lshl_add_u32 v172, v148, 4, v172
    s_mul_i32 s61, s44, 4224
    s_add_u32 s61, s61, 144896
    v_add_u32 v172, s61, v172
    v_lshrrev_b32 v183, 5, v0
    v_and_b32 v171, 31, v0
    v_mul_u32_u24 v173, 528, v183
    v_lshl_add_u32 v173, v171, 4, v173
    v_add_u32 v173, 144896, v173
    v_lshlrev_b32 v181, 3, v183
    v_add_u32 v181, 143616, v181
    s_lshl_b32 s62, s44, 6
    s_add_u32 s62, s62, 143616
    v_lshl_add_u32 v182, v178, 3, s62
    v_lshrrev_b32 v174, 3, v0
    v_lshlrev_b32 v174, 12, v174
    v_lshl_add_u32 v174, v178, 4, v174
    s_lshl_b32 s64, s49, 17
    s_lshl_b32 s62, s54, 7
    s_add_u32 s64, s64, s62
    s_add_u32 s64, s64, 819200
    v_lshrrev_b32 v241, 5, v1
    v_lshlrev_b32 v241, 7, v241
    v_lshl_add_u32 v241, v178, 4, v241
    v_and_b32 v171, 1, v148
    v_lshl_add_u32 v241, v171, 3, v241
    v_bfe_u32 v171, v1, 3, 1
    v_lshl_add_u32 v241, v171, 15, v241
    v_bfe_u32 v177, v1, 3, 1
    v_lshlrev_b32 v177, 14, v177
    v_lshl_add_u32 v177, v178, 4, v177
    s_lshl_b32 s68, s38, 9
    s_lshl_b32 s60, s44, 7
    s_add_u32 s68, s68, s60
    s_add_u32 s68, s68, 3211264
    s_and_b32 s63, s49, 3
    s_lshl_b32 s63, s63, 15
    s_add_u32 s68, s68, s63
    s_add_u32 s60, s60, 143872
    v_lshl_add_u32 v176, v149, 3, s60
    v_and_b32 v175, 1, v1
    v_lshlrev_b32 v175, 6, v175
    v_lshl_add_u32 v175, v148, 3, v175
    v_add_u32 v175, 143872, v175
    v_lshrrev_b32 v179, 3, v1
    v_lshlrev_b32 v179, 12, v179
    v_lshl_add_u32 v179, v178, 4, v179
    s_lshl_b32 s61, s49, 2
    s_add_u32 s61, s61, s44
    s_lshl_b32 s61, s61, 14
    s_add_u32 s61, s61, s62
    s_add_u32 s61, s61, 1867776
    v_and_b32 v180, 3, v1
    v_lshlrev_b32 v180, 4, v180
    v_add_u32 v180, 161792, v180
    v_and_b32 v184, 0xfff, v12
    s_lshl_b32 s62, s44, 6
    v_xor_b32 v184, s62, v184
    v_xor_b32 v185, 32, v184
    v_add_u32 v186, 0x10000, v184
    v_add_u32 v187, 0x10000, v185
    v_xor_b32 v188, 0x6000, v184
    v_xor_b32 v189, 0x6000, v185
    v_xor_b32 v190, 0x6000, v186
    v_xor_b32 v191, 0x6000, v187
    v_mov_b32 v199, s48
    s_mov_b32 s31, 0
    s_waitcnt vmcnt(0)
    v_xor_b32 v200, s48, v209
    v_xor_b32 v201, s48, v211
    v_xor_b32 v202, s48, v213
    v_or3_b32 v200, v200, v201, v202
    v_xor_b32 v201, s48, v215
    v_xor_b32 v202, s48, v217
    v_or3_b32 v200, v200, v201, v202
    v_xor_b32 v201, s48, v219
    v_xor_b32 v202, s48, v221
    v_or3_b32 v200, v200, v201, v202
    v_xor_b32 v201, s48, v223
    v_xor_b32 v202, s48, v225
    v_or3_b32 v200, v200, v201, v202
    v_xor_b32 v201, s48, v227
    v_xor_b32 v202, s48, v229
    v_or3_b32 v200, v200, v201, v202
    v_xor_b32 v201, s48, v231
    v_xor_b32 v202, s48, v233
    v_or3_b32 v200, v200, v201, v202
    v_xor_b32 v201, s48, v235
    v_xor_b32 v202, s48, v237
    v_or3_b32 v200, v200, v201, v202
    v_xor_b32 v201, s48, v239
    v_xor_b32 v202, s48, v205
    v_or3_b32 v200, v200, v201, v202
    v_cmp_ne_u32 vcc, 0, v200
    s_cbranch_vccnz L_h_try
    v_cmp_ne_u32 vcc, s32, v204
    v_mov_b32 v152, v208
    v_mov_b32 v153, v210
    v_mov_b32 v154, v212
    v_mov_b32 v155, v214
    v_mov_b32 v156, v216
    v_mov_b32 v157, v218
    v_mov_b32 v158, v220
    v_mov_b32 v159, v222
    v_mov_b32 v160, v224
    v_mov_b32 v161, v226
    v_mov_b32 v162, v228
    v_mov_b32 v163, v230
    v_mov_b32 v164, v232
    v_mov_b32 v165, v234
    v_mov_b32 v166, v236
    v_mov_b32 v167, v238
    s_cmp_eq_u64 vcc, 0
    s_cselect_b32 s30, 1, 0
    v_lshlrev_b32 v70, 16, v70
    v_lshlrev_b32 v71, 16, v71
    s_branch L_pv
L_last:
    s_cmp_lg_u32 s71, 0
    s_cbranch_scc1 L_lt_31
    s_add_u32 s62, s73, 4096
    buffer_load_dwordx4 v[248:251], v240, s[40:43], s73 offen offset:0 sc1
    buffer_load_dwordx4 v[248:251], v240, s[40:43], s73 offen offset:1024 sc1
    buffer_load_dwordx4 v[248:251], v240, s[40:43], s73 offen offset:2048 sc1
    buffer_load_dwordx4 v[248:251], v240, s[40:43], s73 offen offset:3072 sc1
    buffer_load_dwordx4 v[248:251], v240, s[40:43], s62 offen offset:0 sc1
    buffer_load_dwordx4 v[248:251], v240, s[40:43], s62 offen offset:1024 sc1
    buffer_load_dwordx4 v[248:251], v240, s[40:43], s62 offen offset:2048 sc1
    buffer_load_dwordx4 v[248:251], v240, s[40:43], s62 offen offset:3072 sc1
L_lt_31:
    v_mov_b32 v183, v69
    s_nop 1
    v_permlane16_swap_b32 v69, v183
    s_nop 0
    v_add_f32 v69, v69, v183
    v_mov_b32 v183, v69
    s_nop 1
    v_permlane32_swap_b32 v69, v183
    s_nop 0
    v_add_f32 v69, v69, v183
    ds_write_b64 v182, v[68:69]
    s_mov_b64 exec, 1
    ds_add_u32 v3, v4 offset:24
    s_mov_b64 exec, -1
    s_mov_b32 s62, 0
L_pw_32:
    s_cmp_ge_i32 s62, 4
    s_cbranch_scc1 L_pk_33
    ds_read_b32 v5, v3 offset:24
    s_add_u32 s70, s70, 1
    s_cmp_gt_u32 s70, 0x400000
    s_cbranch_scc1 L_end
    s_waitcnt lgkmcnt(0)
    v_readfirstlane_b32 s62, v5
    s_branch L_pw_32
L_pk_33:
    ds_read2_b64 v[200:203], v181 offset0:0 offset1:8
    ds_read2_b64 v[204:207], v181 offset0:16 offset1:24
    s_waitcnt lgkmcnt(0)
    v_max3_f32 v168, v200, v202, v204
    v_max_f32 v168, v168, v206
    v_sub_f32 v200, v200, v168
    v_sub_f32 v202, v202, v168
    v_sub_f32 v204, v204, v168
    v_sub_f32 v206, v206, v168
    v_exp_f32 v200, v200
    v_exp_f32 v202, v202
    v_exp_f32 v204, v204
    v_exp_f32 v206, v206
    s_nop 0
    v_mul_f32 v169, v200, v201
    v_fmac_f32 v169, v202, v203
    v_fmac_f32 v169, v204, v205
    v_fmac_f32 v169, v206, v207
    v_rcp_f32 v170, v169
    v_log_f32 v169, v169
    s_nop 0
    v_mul_f32 v192, v200, v170
    v_mul_f32 v193, v202, v170
    v_mul_f32 v194, v204, v170
    v_mul_f32 v195, v206, v170
    v_add_f32 v198, v169, v168
    s_branch L_pv
L_loop_done:
    s_nop 5
    ds_write_b128 v172, v[36:39] offset:0
    ds_write_b128 v172, v[40:43] offset:64
    ds_write_b128 v172, v[44:47] offset:128
    ds_write_b128 v172, v[48:51] offset:192
    ds_write_b128 v172, v[52:55] offset:256
    ds_write_b128 v172, v[56:59] offset:320
    ds_write_b128 v172, v[60:63] offset:384
    ds_write_b128 v172, v[64:67] offset:448
    s_mov_b64 exec, 1
    ds_add_u32 v3, v4 offset:12
    s_mov_b64 exec, -1
    s_mov_b32 s62, 0
L_pw_34:
    s_cmp_ge_i32 s62, 4
    s_cbranch_scc1 L_pk_35
    ds_read_b32 v5, v3 offset:12
    s_add_u32 s70, s70, 1
    s_cmp_gt_u32 s70, 0x400000
    s_cbranch_scc1 L_end
    s_waitcnt lgkmcnt(0)
    v_readfirstlane_b32 s62, v5
    s_branch L_pw_34
L_pk_35:
    ds_read_b128 v[200:203], v173 offset:0
    ds_read_b128 v[204:207], v173 offset:4224
    ds_read_b128 v[208:211], v173 offset:8448
    ds_read_b128 v[212:215], v173 offset:12672
    s_waitcnt lgkmcnt(3)
    v_mul_f32 v216, v200, v192
    v_mul_f32 v217, v201, v192
    v_mul_f32 v218, v202, v192
    v_mul_f32 v219, v203, v192
    s_waitcnt lgkmcnt(2)
    v_fmac_f32 v216, v204, v193
    v_fmac_f32 v217, v205, v193
    v_fmac_f32 v218, v206, v193
    v_fmac_f32 v219, v207, v193
    s_waitcnt lgkmcnt(1)
    v_fmac_f32 v216, v208, v194
    v_fmac_f32 v217, v209, v194
    v_fmac_f32 v218, v210, v194
    v_fmac_f32 v219, v211, v194
    s_waitcnt lgkmcnt(0)
    v_fmac_f32 v216, v212, v195
    v_fmac_f32 v217, v213, v195
    v_fmac_f32 v218, v214, v195
    v_fmac_f32 v219, v215, v195
    v_cvt_pk_bf16_f32 v196, v216, v217
    v_cvt_pk_bf16_f32 v197, v218, v219
    s_cmp_eq_u32 s30, 0
    s_cbranch_scc1 L_sl_36
    buffer_store_dwordx4 v[196:199], v174, s[40:43], s64 offen
    s_branch L_sd_37
L_sl_36:
    buffer_store_dwordx4 v[196:199], v174, s[40:43], s64 offen sc1
L_sd_37:
    s_mov_b64 exec, 1
    ds_add_u32 v3, v4 offset:20
    s_mov_b64 exec, -1
    s_cmp_lg_u32 s71, 0
    s_cbranch_scc1 L_fin_done
    s_add_u32 s63, s73, 4096
    v_mov_b64 v[104:105], 0
    v_mov_b64 v[106:107], 0
    v_mov_b64 v[108:109], 0
    v_mov_b64 v[110:111], 0
L_al_38:
    ds_read_b32 v5, v180
    s_add_u32 s70, s70, 1
    s_cmp_gt_u32 s70, 0x400000
    s_cbranch_scc1 L_end
    s_waitcnt lgkmcnt(0)
    v_cmp_gt_i32 vcc, 42, v5
    s_cbranch_vccnz L_al_38
    s_mov_b64 s[6:7], -1
    s_mov_b64 s[8:9], -1
    s_mov_b64 s[10:11], -1
    s_mov_b64 s[12:13], -1
    s_mov_b64 s[14:15], -1
    s_mov_b64 s[16:17], -1
    s_mov_b64 s[18:19], -1
    s_mov_b64 s[20:21], -1
L_o_try:
    s_mov_b64 exec, s[6:7]
    s_cbranch_execz L_o_skip0
    buffer_load_dwordx4 v[116:119], v240, s[40:43], s73 offen offset:0 sc1
L_o_skip0:
    s_mov_b64 exec, s[8:9]
    s_cbranch_execz L_o_skip1
    buffer_load_dwordx4 v[120:123], v240, s[40:43], s73 offen offset:1024 sc1
L_o_skip1:
    s_mov_b64 exec, s[10:11]
    s_cbranch_execz L_o_skip2
    buffer_load_dwordx4 v[124:127], v240, s[40:43], s73 offen offset:2048 sc1
L_o_skip2:
    s_mov_b64 exec, s[12:13]
    s_cbranch_execz L_o_skip3
    buffer_load_dwordx4 v[128:131], v240, s[40:43], s73 offen offset:3072 sc1
L_o_skip3:
    s_mov_b64 exec, s[14:15]
    s_cbranch_execz L_o_skip4
    buffer_load_dwordx4 v[132:135], v240, s[40:43], s63 offen offset:0 sc1
L_o_skip4:
    s_mov_b64 exec, s[16:17]
    s_cbranch_execz L_o_skip5
    buffer_load_dwordx4 v[136:139], v240, s[40:43], s63 offen offset:1024 sc1
L_o_skip5:
    s_mov_b64 exec, s[18:19]
    s_cbranch_execz L_o_skip6
    buffer_load_dwordx4 v[140:143], v240, s[40:43], s63 offen offset:2048 sc1
L_o_skip6:
    s_mov_b64 exec, s[20:21]
    s_cbranch_execz L_o_skip7
    buffer_load_dwordx4 v[144:147], v240, s[40:43], s63 offen offset:3072 sc1
L_o_skip7:
    s_mov_b64 exec, -1
    s_add_u32 s70, s70, 1
    s_cmp_gt_u32 s70, 0x400000
    s_cbranch_scc1 L_end
    s_waitcnt vmcnt(0)
    v_cmp_ne_u32 s[6:7], s48, v119
    v_cmp_ne_u32 s[8:9], s48, v123
    v_cmp_ne_u32 s[10:11], s48, v127
    v_cmp_ne_u32 s[12:13], s48, v131
    v_cmp_ne_u32 s[14:15], s48, v135
    v_cmp_ne_u32 s[16:17], s48, v139
    v_cmp_ne_u32 s[18:19], s48, v143
    v_cmp_ne_u32 s[20:21], s48, v147
    s_or_b64 s[66:67], s[6:7], s[8:9]
    s_or_b64 s[66:67], s[66:67], s[10:11]
    s_or_b64 s[66:67], s[66:67], s[12:13]
    s_or_b64 s[66:67], s[66:67], s[14:15]
    s_or_b64 s[66:67], s[66:67], s[16:17]
    s_or_b64 s[66:67], s[66:67], s[18:19]
    s_or_b64 s[66:67], s[66:67], s[20:21]
    s_cbranch_scc1 L_o_try
    v_max3_f32 v168, v118, v122, v126
    v_max3_f32 v169, v134, v138, v142
    v_max_f32 v168, v168, v130
    v_max_f32 v169, v169, v146
    v_and_b32 v119, 0xffff0000, v117
    v_lshlrev_b32 v225, 16, v117
    v_and_b32 v117, 0xffff0000, v116
    v_lshlrev_b32 v116, 16, v116
    v_max_f32_dpp v168, v168, v168 row_ror:8 row_mask:0xf bank_mask:0xf
    v_max_f32_dpp v169, v169, v169 row_ror:8 row_mask:0xf bank_mask:0xf
    v_mov_b32 v170, v168
    v_mov_b32 v171, v169
    v_and_b32 v123, 0xffff0000, v121
    v_lshlrev_b32 v227, 16, v121
    v_and_b32 v121, 0xffff0000, v120
    v_lshlrev_b32 v120, 16, v120
    v_permlane16_swap_b32 v168, v170
    v_permlane16_swap_b32 v169, v171
    v_max_f32 v168, v168, v170
    v_max_f32 v169, v169, v171
    v_mov_b32 v170, v168
    v_mov_b32 v171, v169
    v_and_b32 v127, 0xffff0000, v125
    v_lshlrev_b32 v229, 16, v125
    v_and_b32 v125, 0xffff0000, v124
    v_lshlrev_b32 v124, 16, v124
    v_permlane32_swap_b32 v168, v170
    v_permlane32_swap_b32 v169, v171
    v_max_f32 v168, v168, v170
    v_max_f32 v169, v169, v171
    v_sub_f32 v224, v118, v168
    v_sub_f32 v226, v122, v168
    v_sub_f32 v228, v126, v168
    v_sub_f32 v230, v130, v168
    v_sub_f32 v232, v134, v169
    v_sub_f32 v234, v138, v169
    v_sub_f32 v236, v142, v169
    v_sub_f32 v238, v146, v169
    v_exp_f32 v224, v224
    v_exp_f32 v226, v226
    v_exp_f32 v228, v228
    v_exp_f32 v230, v230
    v_exp_f32 v232, v232
    v_exp_f32 v234, v234
    v_exp_f32 v236, v236
    v_exp_f32 v238, v238
    v_and_b32 v131, 0xffff0000, v129
    v_lshlrev_b32 v231, 16, v129
    v_and_b32 v129, 0xffff0000, v128
    v_lshlrev_b32 v128, 16, v128
    v_and_b32 v135, 0xffff0000, v133
    v_lshlrev_b32 v233, 16, v133
    v_and_b32 v133, 0xffff0000, v132
    v_lshlrev_b32 v132, 16, v132
    v_and_b32 v139, 0xffff0000, v137
    v_lshlrev_b32 v235, 16, v137
    v_and_b32 v137, 0xffff0000, v136
    v_lshlrev_b32 v136, 16, v136
    v_and_b32 v143, 0xffff0000, v141
    v_lshlrev_b32 v237, 16, v141
    v_and_b32 v141, 0xffff0000, v140
    v_lshlrev_b32 v140, 16, v140
    v_and_b32 v147, 0xffff0000, v145
    v_lshlrev_b32 v239, 16, v145
    v_and_b32 v145, 0xffff0000, v144
    v_lshlrev_b32 v144, 16, v144
    v_mul_f32 v200, v116, v224
    v_mul_f32 v201, v117, v224
    v_mul_f32 v202, v225, v224
    v_mul_f32 v203, v119, v224
    v_add_f32 v204, v224, v226
    v_mul_f32 v208, v132, v232
    v_mul_f32 v209, v133, v232
    v_mul_f32 v210, v233, v232
    v_mul_f32 v211, v135, v232
    v_add_f32 v212, v232, v234
    v_fmac_f32 v200, v120, v226
    v_fmac_f32 v201, v121, v226
    v_fmac_f32 v202, v227, v226
    v_fmac_f32 v203, v123, v226
    v_fmac_f32 v208, v136, v234
    v_fmac_f32 v209, v137, v234
    v_fmac_f32 v210, v235, v234
    v_fmac_f32 v211, v139, v234
    v_fmac_f32 v200, v124, v228
    v_fmac_f32 v201, v125, v228
    v_fmac_f32 v202, v229, v228
    v_fmac_f32 v203, v127, v228
    v_add_f32 v204, v204, v228
    v_fmac_f32 v208, v140, v236
    v_fmac_f32 v209, v141, v236
    v_fmac_f32 v210, v237, v236
    v_fmac_f32 v211, v143, v236
    v_add_f32 v212, v212, v236
    v_fmac_f32 v200, v128, v230
    v_fmac_f32 v201, v129, v230
    v_fmac_f32 v202, v231, v230
    v_fmac_f32 v203, v131, v230
    v_add_f32 v204, v204, v230
    v_fmac_f32 v208, v144, v238
    v_fmac_f32 v209, v145, v238
    v_fmac_f32 v210, v239, v238
    v_fmac_f32 v211, v147, v238
    v_add_f32 v212, v212, v238
    s_nop 0
    v_permlane32_swap_b32 v200, v208
    v_permlane32_swap_b32 v201, v209
    v_permlane32_swap_b32 v202, v210
    v_permlane32_swap_b32 v203, v211
    v_permlane32_swap_b32 v204, v212
    v_add_f32 v204, v204, v212
    v_mov_b32 v205, v204
    v_add_f32 v200, v200, v208
    v_add_f32 v201, v201, v209
    v_add_f32 v202, v202, v210
    v_add_f32 v203, v203, v211
    v_permlane16_swap_b32 v204, v205
    v_permlane16_swap_b32 v200, v202
    v_permlane16_swap_b32 v201, v203
    v_add_f32 v204, v204, v205
    v_add_f32 v200, v200, v202
    v_add_f32 v201, v201, v203
    v_add_f32_dpp v204, v204, v204 row_ror:8 row_mask:0xf bank_mask:0xf
    v_add_f32_dpp v200, v200, v200 row_ror:8 row_mask:0xf bank_mask:0xf
    v_add_f32_dpp v201, v201, v201 row_ror:8 row_mask:0xf bank_mask:0xf
    v_rcp_f32 v204, v204
    v_mov_b32 v203, s48
    v_mul_f32 v200, v200, v204
    v_mul_f32 v201, v201, v204
    v_cvt_pk_bf16_f32 v202, v200, v201
    buffer_store_dwordx2 v[202:203], v241, s[40:43], s72 offen sc1
    s_add_u32 s72, s72, 65536
    buffer_store_dwordx2 v[202:203], v241, s[40:43], s72 offen sc1
    s_mov_b64 exec, -1
    s_branch L_wd_done
L_fin_done:
L_al_39:
    ds_read_b32 v5, v180
    s_add_u32 s70, s70, 1
    s_cmp_gt_u32 s70, 0x400000
    s_cbranch_scc1 L_end
    s_waitcnt lgkmcnt(0)
    v_cmp_gt_i32 vcc, 40, v5
    s_cbranch_vccnz L_al_39
    buffer_load_dwordx4 v[116:119], v177, s[40:43], s68 offen sc1
    s_lshl_b32 s62, s44, 10
    s_add_u32 s62, s74, s62
    buffer_load_dwordx4 v[120:123], v240, s[40:43], s62 offen sc1
    ds_read_b64_tr_b16 v[36:37], v188 offset:0
    ds_read_b64_tr_b16 v[38:39], v188 offset:4096
    ds_read_b64_tr_b16 v[40:41], v189 offset:0
    ds_read_b64_tr_b16 v[42:43], v189 offset:4096
    ds_read_b64_tr_b16 v[44:45], v188 offset:32768
    ds_read_b64_tr_b16 v[46:47], v188 offset:36864
    ds_read_b64_tr_b16 v[48:49], v189 offset:32768
    ds_read_b64_tr_b16 v[50:51], v189 offset:36864
    ds_read_b64_tr_b16 v[52:53], v190 offset:0
    ds_read_b64_tr_b16 v[54:55], v190 offset:4096
    ds_read_b64_tr_b16 v[56:57], v191 offset:0
    ds_read_b64_tr_b16 v[58:59], v191 offset:4096
    ds_read_b64_tr_b16 v[60:61], v190 offset:32768
    ds_read_b64_tr_b16 v[62:63], v190 offset:36864
    ds_read_b64_tr_b16 v[64:65], v191 offset:32768
    ds_read_b64_tr_b16 v[66:67], v191 offset:36864
    s_waitcnt lgkmcnt(12)
    v_mfma_f32_16x16x32_bf16 v[104:107], v[152:155], v[36:39], 0
    v_mfma_f32_16x16x32_bf16 v[108:111], v[152:155], v[40:43], 0
    s_waitcnt lgkmcnt(8)
    v_mfma_f32_16x16x32_bf16 v[104:107], v[156:159], v[44:47], v[104:107]
    v_mfma_f32_16x16x32_bf16 v[108:111], v[156:159], v[48:51], v[108:111]
    s_waitcnt lgkmcnt(4)
    v_mfma_f32_16x16x32_bf16 v[104:107], v[160:163], v[52:55], v[104:107]
    v_mfma_f32_16x16x32_bf16 v[108:111], v[160:163], v[56:59], v[108:111]
    s_waitcnt lgkmcnt(0)
    v_mfma_f32_16x16x32_bf16 v[104:107], v[164:167], v[60:63], v[104:107]
    v_mfma_f32_16x16x32_bf16 v[108:111], v[164:167], v[64:67], v[108:111]
L_wd_done:
    v_mov_b32 v197, s48
    s_mov_b32 s66, 0xffff0000
    s_mov_b32 s67, 0
L_al_40:
    ds_read_b32 v5, v180
    s_add_u32 s70, s70, 1
    s_cmp_gt_u32 s70, 0x400000
    s_cbranch_scc1 L_end
    s_waitcnt lgkmcnt(0)
    v_cmp_gt_i32 vcc, 42, v5
    s_cbranch_vccnz L_al_40
    ds_read_b64_tr_b16 v[36:37], v184 offset:0
    ds_read_b64_tr_b16 v[38:39], v184 offset:4096
    ds_read_b64_tr_b16 v[40:41], v185 offset:0
    ds_read_b64_tr_b16 v[42:43], v185 offset:4096
    ds_read_b64_tr_b16 v[44:45], v184 offset:32768
    ds_read_b64_tr_b16 v[46:47], v184 offset:36864
    ds_read_b64_tr_b16 v[48:49], v185 offset:32768
    ds_read_b64_tr_b16 v[50:51], v185 offset:36864
    ds_read_b64_tr_b16 v[52:53], v186 offset:0
    ds_read_b64_tr_b16 v[54:55], v186 offset:4096
    ds_read_b64_tr_b16 v[56:57], v187 offset:0
    ds_read_b64_tr_b16 v[58:59], v187 offset:4096
    ds_read_b64_tr_b16 v[60:61], v186 offset:32768
    ds_read_b64_tr_b16 v[62:63], v186 offset:36864
    ds_read_b64_tr_b16 v[64:65], v187 offset:32768
    ds_read_b64_tr_b16 v[66:67], v187 offset:36864
    s_cmp_lg_u32 s71, 0
    s_cbranch_scc1 L_og_chk
    s_lshl_b32 s62, s44, 10
    s_add_u32 s62, s74, s62
    buffer_load_dwordx4 v[120:123], v240, s[40:43], s62 offen sc1
L_og_try:
    buffer_load_dwordx4 v[116:119], v177, s[40:43], s68 offen sc1
L_og_chk:
    s_add_u32 s70, s70, 1
    s_cmp_gt_u32 s70, 0x400000
    s_cbranch_scc1 L_end
    s_waitcnt vmcnt(0)
    v_xor_b32 v168, s48, v117
    v_xor_b32 v169, s48, v119
    v_or_b32 v168, v168, v169
    v_cmp_ne_u32 vcc, 0, v168
    s_cbranch_vccnz L_og_try
    ds_write2_b32 v176, v116, v118 offset0:0 offset1:1
    s_mov_b64 exec, 1
    ds_add_u32 v3, v4 offset:16
    s_mov_b64 exec, -1
    s_mov_b32 s62, 0
L_pw_41:
    s_cmp_ge_i32 s62, 4
    s_cbranch_scc1 L_pk_42
    ds_read_b32 v5, v3 offset:16
    s_add_u32 s70, s70, 1
    s_cmp_gt_u32 s70, 0x400000
    s_cbranch_scc1 L_end
    s_waitcnt lgkmcnt(0)
    v_readfirstlane_b32 s62, v5
    s_branch L_pw_41
L_pk_42:
    ds_read2_b64 v[72:75], v175 offset0:0 offset1:4
    ds_read2_b64 v[76:79], v175 offset0:16 offset1:20
    ds_read2_b64 v[80:83], v175 offset0:32 offset1:36
    ds_read2_b64 v[84:87], v175 offset0:48 offset1:52
    s_waitcnt lgkmcnt(3)
    v_mfma_f32_16x16x32_bf16 v[104:107], v[72:75], v[36:39], v[104:107]
    v_mfma_f32_16x16x32_bf16 v[108:111], v[72:75], v[40:43], v[108:111]
    s_waitcnt lgkmcnt(2)
    v_mfma_f32_16x16x32_bf16 v[104:107], v[76:79], v[44:47], v[104:107]
    v_mfma_f32_16x16x32_bf16 v[108:111], v[76:79], v[48:51], v[108:111]
    s_waitcnt lgkmcnt(1)
    v_mfma_f32_16x16x32_bf16 v[104:107], v[80:83], v[52:55], v[104:107]
    v_mfma_f32_16x16x32_bf16 v[108:111], v[80:83], v[56:59], v[108:111]
    s_waitcnt lgkmcnt(0)
    v_mfma_f32_16x16x32_bf16 v[104:107], v[84:87], v[60:63], v[104:107]
    v_mfma_f32_16x16x32_bf16 v[108:111], v[84:87], v[64:67], v[108:111]
    s_nop 7
    v_cndmask_b32 v196, v104, v108, s[66:67]
    v_cndmask_b32 v198, v105, v109, s[66:67]
    s_mov_b32 exec_hi, 0
    s_cmp_eq_u32 s30, 0
    s_cbranch_scc1 L_sl_43
    buffer_store_dwordx4 v[196:199], v179, s[40:43], s61 offen
    s_branch L_sd_44
L_sl_43:
    buffer_store_dwordx4 v[196:199], v179, s[40:43], s61 offen sc1
L_sd_44:
    s_mov_b64 exec, -1
    s_cmp_lg_u32 s44, 0
    s_cbranch_scc1 L_end
    s_cmp_ge_u32 s2, 128
    s_cbranch_scc1 L_end
L_r_try:
    buffer_load_dwordx4 v[116:119], v240, s[40:43], s74 offen offset:0 sc1
    buffer_load_dwordx4 v[120:123], v240, s[40:43], s74 offen offset:1024 sc1
    buffer_load_dwordx4 v[124:127], v240, s[40:43], s74 offen offset:2048 sc1
    buffer_load_dwordx4 v[128:131], v240, s[40:43], s74 offen offset:3072 sc1
    s_add_u32 s70, s70, 1
    s_cmp_gt_u32 s70, 0x400000
    s_cbranch_scc1 L_end
    s_waitcnt vmcnt(0)
    v_xor_b32 v168, s48, v117
    v_xor_b32 v169, s48, v119
    v_xor_b32 v170, s48, v121
    v_or3_b32 v168, v168, v169, v170
    v_xor_b32 v169, s48, v123
    v_xor_b32 v170, s48, v125
    v_or3_b32 v168, v168, v169, v170
    v_xor_b32 v169, s48, v127
    v_xor_b32 v170, s48, v129
    v_or3_b32 v168, v168, v169, v170
    v_xor_b32 v169, s48, v131
    v_or_b32 v168, v168, v169
    v_cmp_ne_u32 vcc, 0, v168
    s_cbranch_vccnz L_r_try
    v_add_f32 v116, v116, v120
    v_add_f32 v124, v124, v128
    v_add_f32 v118, v118, v122
    v_add_f32 v126, v126, v130
    v_add_f32 v116, v116, v124
    v_add_f32 v118, v118, v126
    s_nop 0
    v_add_f32_dpp v116, v116, v116 row_ror:8 row_mask:0xf bank_mask:0xf
    v_add_f32_dpp v118, v118, v118 row_ror:8 row_mask:0xf bank_mask:0xf
    v_mov_b32 v168, v116
    v_mov_b32 v169, v118
    s_nop 1
    v_permlane16_swap_b32 v116, v168
    v_permlane16_swap_b32 v118, v169
    v_add_f32 v116, v116, v168
    v_add_f32 v118, v118, v169
    v_mov_b32 v168, v116
    v_mov_b32 v169, v118
    s_nop 1
    v_permlane32_swap_b32 v116, v168
    v_permlane32_swap_b32 v118, v169
    v_add_f32 v116, v116, v168
    v_add_f32 v118, v118, v169
    v_add_f32 v116, v116, v70
    v_add_f32 v118, v118, v71
    v_cvt_pk_bf16_f32 v116, v116, v118
    s_mov_b64 exec, 0xff
    global_store_short v242, v116, s[22:23]
    global_store_short_d16_hi v242, v116, s[22:23] offset:2048
    s_cmp_lg_u32 s2, 0
    s_cbranch_scc1 L_end
    s_mov_b64 exec, 1
    v_mov_b32 v172, 0
    v_mov_b32 v173, s48
    buffer_store_dword v173, v172, s[40:43], 0 offen sc1
L_end:
    s_endpgm
.section .rodata,"a"
.p2align 6
.amdhsa_kernel parallel_sum__gqa_block_cached__geglu_ffn__decode_kernel
  .amdhsa_next_free_vgpr 256
  .amdhsa_next_free_sgpr 102
  .amdhsa_accum_offset 256
  .amdhsa_group_segment_fixed_size 0
  .amdhsa_kernarg_size 96
  .amdhsa_user_sgpr_count 2
  .amdhsa_user_sgpr_kernarg_segment_ptr 1
  .amdhsa_system_sgpr_workgroup_id_x 1
  .amdhsa_float_denorm_mode_32 3
.end_amdhsa_kernel
```
